```python
import torch

def _softmax(x, axis=-1):
    return torch.softmax(x, dim=axis)
def _gelu(x):
    return torch.nn.functional.gelu(x, approximate="tanh")
def _silu(x):
    return torch.nn.functional.silu(x)
def _sigmoid(x):
    return torch.sigmoid(x)
def _layernorm(x, axis=-1, eps=1e-5):
    m = x.mean(dim=axis, keepdim=True)
    v = x.var(dim=axis, keepdim=True, unbiased=False)
    return (x - m) / torch.sqrt(v + eps)
def _scatter_add(tgt, idx, src, axis=0):
    return tgt.clone().index_add_(axis, idx, src)
def _segment_sum(src, seg, n):
    out = torch.zeros((n,) + src.shape[1:], dtype=src.dtype)
    return out.index_add_(0, seg, src)
def _pad(x, pw):
    flat = tuple(v for pair in reversed(pw) for v in pair)
    return torch.nn.functional.pad(x, flat)

kernel_name = 'concat_heads__sliding_block__softmax_full_mha__prompt'

def setup_inputs():

    _w = (lambda a: (lambda t: t.to(torch.bfloat16) if t.is_floating_point() else t)(torch.as_tensor(a)))
    def _A_setup():
        B, S, D = 1, 2048, 512
        return {
            "x": _w((lambda *s: torch.randn(*s, dtype=torch.bfloat16) * 0.4)(B, S, D)),
            "wqkv": _w((lambda *s: torch.randn(*s, dtype=torch.bfloat16) * 0.4)(D, 3 * D)),
            "wo": _w((lambda *s: torch.randn(*s, dtype=torch.bfloat16) * 0.05)(D, D)),
        }
    _A_in = _A_setup()

    def _B_setup():
        B, S, D = 1, 2048, 512
        return {
            "x": _w((lambda *s: torch.randn(*s, dtype=torch.bfloat16) * 0.2)(B, S, D)),
            "wqkv": _w((lambda *s: torch.randn(*s, dtype=torch.bfloat16) * 0.4)(D, 3 * D)),
            "wo": _w((lambda *s: torch.randn(*s, dtype=torch.bfloat16) * 0.1)(D, D)),
        }
    _B_in = _B_setup()

    return {
        "A_x": _A_in["x"],
        "A_wqkv": _A_in["wqkv"],
        "A_wo": _A_in["wo"],
        "B_x": _B_in["x"],
        "B_wqkv": _B_in["wqkv"],
        "B_wo": _B_in["wo"],
    }

def reference(A_x, A_wqkv, A_wo, B_x, B_wqkv, B_wo):
    def _A_ref(x, wqkv, wo):
        B, S, D = x.shape
        H = 32; Dh = D // H; W = 256
        qkv = (lambda x, *d: x.permute(*d))((x @ wqkv).reshape(B, S, 3, H, Dh), 2, 0, 3, 1, 4)
        q, k, v = qkv[0], qkv[1], qkv[2]
        scores = torch.einsum("bhqd,bhkd->bhqk", q, k) * (Dh ** -0.5)
        idx = torch.arange(S)
        mask = (idx[:, None] - idx[None, :] >= 0) & (idx[:, None] - idx[None, :] < W)
        scores = torch.where(mask[None, None], scores, -1e9)
        p = _softmax(scores, axis=-1)
        o = torch.einsum("bhqk,bhkd->bhqd", p, v)
        return (lambda x, *d: x.permute(*d))(o, 0, 2, 1, 3).reshape(B, S, D) @ wo

    def _B_ref(x, wqkv, wo):
        B, S, D = x.shape
        H = 32; Dh = D // H
        qkv = (lambda x, *d: x.permute(*d))((x @ wqkv).reshape(B, S, 3, H, Dh), 2, 0, 3, 1, 4)
        q, k, v = qkv[0], qkv[1], qkv[2]
        scale = Dh ** -0.5
        scores = torch.einsum("bhqd,bhkd->bhqk", q, k) * scale
        p = _softmax(scores, axis=-1)
        o = torch.einsum("bhqk,bhkd->bhqd", p, v)
        return (lambda x, *d: x.permute(*d))(o, 0, 2, 1, 3).reshape(B, S, D) @ wo

    a = _A_ref(A_x, A_wqkv, A_wo)
    b = _B_ref(B_x, B_wqkv, B_wo)
    return torch.concatenate([a, b], axis=-1)
```

```asm
; @launch kernel=qkv_kernel grid=(384,1,1) block=(256,1,1) lds=77824
; @launch kernel=attn_kernel grid=(512,1,1) block=(512,1,1) lds=57344
; @launch kernel=outp_kernel grid=(256,1,1) block=(256,1,1) lds=98304
.amdgcn_target "amdgcn-amd-amdhsa--gfx950"
.text
.globl qkv_kernel
.p2align 8
.type qkv_kernel,@function
qkv_kernel:

    s_cmp_ge_u32 s2, 384
    s_cbranch_scc1 L_qkv_done
    s_load_dwordx4 s[4:7], s[0:1], 0
    s_load_dwordx4 s[8:11], s[0:1], 24
    s_load_dwordx2 s[24:25], s[0:1], 64
    s_cmp_ge_u32 s2, 192
    s_cselect_b32 s26, 1, 0
    s_cselect_b32 s27, 192, 0
    s_sub_u32 s27, s2, s27
    s_lshr_b32 s28, s27, 4
    s_and_b32 s29, s27, 15
    s_lshr_b32 s30, s28, 2
    s_and_b32 s31, s28, 3
    v_and_b32 v1, 63, v0
    v_lshrrev_b32 v2, 6, v0
    s_nop 0
    v_readfirstlane_b32 s32, v2
    s_waitcnt lgkmcnt(0)
    s_cmp_eq_u32 s26, 0
    s_cselect_b32 s12, s4, s8
    s_cselect_b32 s13, s5, s9
    s_cselect_b32 s16, s6, s10
    s_cselect_b32 s17, s7, s11
    s_mov_b32 s14, 0x200000
    s_mov_b32 s15, 0x00020000
    s_mov_b32 s18, 0x180000
    s_mov_b32 s19, 0x00020000
    s_mov_b32 s20, s24
    s_mov_b32 s21, s25
    s_mov_b32 s22, 16777216
    s_mov_b32 s23, 0x00020000
    s_and_b32 s33, s32, 1
    s_lshr_b32 s34, s32, 1
    v_lshrrev_b32 v3, 3, v0
    v_and_b32 v4, 7, v0
    v_lshlrev_b32 v5, 10, v3
    v_lshl_add_u32 v5, v4, 4, v5
    s_lshl_b32 s35, s29, 17
    v_add_u32 v5, s35, v5
    v_mul_u32_u24 v6, 144, v3
    v_lshl_add_u32 v6, v4, 4, v6
    v_lshrrev_b32 v3, 4, v0
    v_and_b32 v4, 15, v0
    v_mul_u32_u24 v7, 3072, v3
    v_lshl_add_u32 v7, v4, 4, v7
    s_lshl_b32 s35, s28, 8
    v_add_u32 v7, s35, v7
    v_mul_u32_u24 v8, 320, v3
    v_lshl_add_u32 v8, v4, 4, v8
    v_add_u32 v8, 18432, v8
    v_and_b32 v3, 31, v1
    v_lshrrev_b32 v4, 5, v1
    s_lshl_b32 s35, s33, 6
    v_add_u32 v9, s35, v3
    v_mul_u32_u24 v9, 144, v9
    v_lshl_add_u32 v9, v4, 4, v9
    v_lshrrev_b32 v10, 5, v1
    v_lshlrev_b32 v10, 3, v10
    v_bfe_u32 v11, v1, 2, 2
    v_add_u32 v10, v10, v11
    v_mul_u32_u24 v10, 320, v10
    v_bfe_u32 v11, v1, 4, 1
    v_lshlrev_b32 v11, 4, v11
    v_and_b32 v12, 3, v1
    v_lshl_add_u32 v11, v12, 2, v11
    s_lshl_b32 s35, s34, 6
    v_add_u32 v11, s35, v11
    v_lshl_add_u32 v10, v11, 1, v10
    v_add_u32 v10, 18432, v10
    v_add_u32 v11, 38912, v10
    s_mov_b32 s40, 0
    s_mov_b32 s41, 32768
    s_mov_b32 s42, 65536
    s_mov_b32 s43, 98304
    v_mov_b32 v64, 0
    v_mov_b32 v65, 0
    v_mov_b32 v66, 0
    v_mov_b32 v67, 0
    v_mov_b32 v68, 0
    v_mov_b32 v69, 0
    v_mov_b32 v70, 0
    v_mov_b32 v71, 0
    v_mov_b32 v72, 0
    v_mov_b32 v73, 0
    v_mov_b32 v74, 0
    v_mov_b32 v75, 0
    v_mov_b32 v76, 0
    v_mov_b32 v77, 0
    v_mov_b32 v78, 0
    v_mov_b32 v79, 0
    v_mov_b32 v80, 0
    v_mov_b32 v81, 0
    v_mov_b32 v82, 0
    v_mov_b32 v83, 0
    v_mov_b32 v84, 0
    v_mov_b32 v85, 0
    v_mov_b32 v86, 0
    v_mov_b32 v87, 0
    v_mov_b32 v88, 0
    v_mov_b32 v89, 0
    v_mov_b32 v90, 0
    v_mov_b32 v91, 0
    v_mov_b32 v92, 0
    v_mov_b32 v93, 0
    v_mov_b32 v94, 0
    v_mov_b32 v95, 0
    v_mov_b32 v96, 0
    v_mov_b32 v97, 0
    v_mov_b32 v98, 0
    v_mov_b32 v99, 0
    v_mov_b32 v100, 0
    v_mov_b32 v101, 0
    v_mov_b32 v102, 0
    v_mov_b32 v103, 0
    v_mov_b32 v104, 0
    v_mov_b32 v105, 0
    v_mov_b32 v106, 0
    v_mov_b32 v107, 0
    v_mov_b32 v108, 0
    v_mov_b32 v109, 0
    v_mov_b32 v110, 0
    v_mov_b32 v111, 0
    v_mov_b32 v112, 0
    v_mov_b32 v113, 0
    v_mov_b32 v114, 0
    v_mov_b32 v115, 0
    v_mov_b32 v116, 0
    v_mov_b32 v117, 0
    v_mov_b32 v118, 0
    v_mov_b32 v119, 0
    v_mov_b32 v120, 0
    v_mov_b32 v121, 0
    v_mov_b32 v122, 0
    v_mov_b32 v123, 0
    v_mov_b32 v124, 0
    v_mov_b32 v125, 0
    v_mov_b32 v126, 0
    v_mov_b32 v127, 0
    s_cmp_eq_u32 s30, 2
    s_cbranch_scc1 L_qkv_vpath
    buffer_load_dwordx4 v[32:35], v5, s[12:15], s40 offen offset:0
    buffer_load_dwordx4 v[36:39], v5, s[12:15], s41 offen offset:0
    buffer_load_dwordx4 v[40:43], v5, s[12:15], s42 offen offset:0
    buffer_load_dwordx4 v[44:47], v5, s[12:15], s43 offen offset:0
    s_mov_b32 s44, 0
    buffer_load_dwordx4 v[48:51], v7, s[16:19], s44 offen
    s_mov_b32 s44, 49152
    buffer_load_dwordx4 v[52:55], v7, s[16:19], s44 offen
    s_mov_b32 s44, 98304
    buffer_load_dwordx4 v[56:59], v7, s[16:19], s44 offen
    s_mov_b32 s44, 147456
    buffer_load_dwordx4 v[60:63], v7, s[16:19], s44 offen
    s_waitcnt vmcnt(0)
    ds_write_b128 v6, v[32:35] offset:0
    ds_write_b128 v6, v[36:39] offset:4608
    ds_write_b128 v6, v[40:43] offset:9216
    ds_write_b128 v6, v[44:47] offset:13824
    ds_write_b128 v8, v[48:51] offset:0
    ds_write_b128 v8, v[52:55] offset:5120
    ds_write_b128 v8, v[56:59] offset:10240
    ds_write_b128 v8, v[60:63] offset:15360
    buffer_load_dwordx4 v[32:35], v5, s[12:15], s40 offen offset:128
    buffer_load_dwordx4 v[36:39], v5, s[12:15], s41 offen offset:128
    buffer_load_dwordx4 v[40:43], v5, s[12:15], s42 offen offset:128
    buffer_load_dwordx4 v[44:47], v5, s[12:15], s43 offen offset:128
    s_mov_b32 s44, 196608
    buffer_load_dwordx4 v[48:51], v7, s[16:19], s44 offen
    s_mov_b32 s44, 245760
    buffer_load_dwordx4 v[52:55], v7, s[16:19], s44 offen
    s_mov_b32 s44, 294912
    buffer_load_dwordx4 v[56:59], v7, s[16:19], s44 offen
    s_mov_b32 s44, 344064
    buffer_load_dwordx4 v[60:63], v7, s[16:19], s44 offen
    s_waitcnt lgkmcnt(0)
    s_barrier
    ds_read_b128 v[16:19], v9 offset:0
    ds_read_b128 v[20:23], v9 offset:4608
    ds_read_b64_tr_b16 v[24:25], v10 offset:0
    ds_read_b64_tr_b16 v[26:27], v10 offset:1280
    ds_read_b64_tr_b16 v[28:29], v10 offset:64
    ds_read_b64_tr_b16 v[30:31], v10 offset:1344
    ds_read_b128 v[128:131], v9 offset:32
    ds_read_b128 v[132:135], v9 offset:4640
    ds_read_b64_tr_b16 v[136:137], v10 offset:5120
    ds_read_b64_tr_b16 v[138:139], v10 offset:6400
    ds_read_b64_tr_b16 v[140:141], v10 offset:5184
    ds_read_b64_tr_b16 v[142:143], v10 offset:6464
    s_waitcnt lgkmcnt(6)
    v_mfma_f32_32x32x16_bf16 v[64:79], v[24:27], v[16:19], v[64:79]
    v_mfma_f32_32x32x16_bf16 v[80:95], v[28:31], v[16:19], v[80:95]
    v_mfma_f32_32x32x16_bf16 v[96:111], v[24:27], v[20:23], v[96:111]
    v_mfma_f32_32x32x16_bf16 v[112:127], v[28:31], v[20:23], v[112:127]
    ds_read_b128 v[16:19], v9 offset:64
    ds_read_b128 v[20:23], v9 offset:4672
    ds_read_b64_tr_b16 v[24:25], v10 offset:10240
    ds_read_b64_tr_b16 v[26:27], v10 offset:11520
    ds_read_b64_tr_b16 v[28:29], v10 offset:10304
    ds_read_b64_tr_b16 v[30:31], v10 offset:11584
    s_waitcnt lgkmcnt(6)
    v_mfma_f32_32x32x16_bf16 v[64:79], v[136:139], v[128:131], v[64:79]
    v_mfma_f32_32x32x16_bf16 v[80:95], v[140:143], v[128:131], v[80:95]
    v_mfma_f32_32x32x16_bf16 v[96:111], v[136:139], v[132:135], v[96:111]
    v_mfma_f32_32x32x16_bf16 v[112:127], v[140:143], v[132:135], v[112:127]
    ds_read_b128 v[128:131], v9 offset:96
    ds_read_b128 v[132:135], v9 offset:4704
    ds_read_b64_tr_b16 v[136:137], v10 offset:15360
    ds_read_b64_tr_b16 v[138:139], v10 offset:16640
    ds_read_b64_tr_b16 v[140:141], v10 offset:15424
    ds_read_b64_tr_b16 v[142:143], v10 offset:16704
    s_waitcnt lgkmcnt(6)
    v_mfma_f32_32x32x16_bf16 v[64:79], v[24:27], v[16:19], v[64:79]
    v_mfma_f32_32x32x16_bf16 v[80:95], v[28:31], v[16:19], v[80:95]
    v_mfma_f32_32x32x16_bf16 v[96:111], v[24:27], v[20:23], v[96:111]
    v_mfma_f32_32x32x16_bf16 v[112:127], v[28:31], v[20:23], v[112:127]
    s_waitcnt lgkmcnt(0)
    v_mfma_f32_32x32x16_bf16 v[64:79], v[136:139], v[128:131], v[64:79]
    v_mfma_f32_32x32x16_bf16 v[80:95], v[140:143], v[128:131], v[80:95]
    v_mfma_f32_32x32x16_bf16 v[96:111], v[136:139], v[132:135], v[96:111]
    v_mfma_f32_32x32x16_bf16 v[112:127], v[140:143], v[132:135], v[112:127]
    s_waitcnt vmcnt(0)
    ds_write_b128 v6, v[32:35] offset:38912
    ds_write_b128 v6, v[36:39] offset:43520
    ds_write_b128 v6, v[40:43] offset:48128
    ds_write_b128 v6, v[44:47] offset:52736
    ds_write_b128 v8, v[48:51] offset:38912
    ds_write_b128 v8, v[52:55] offset:44032
    ds_write_b128 v8, v[56:59] offset:49152
    ds_write_b128 v8, v[60:63] offset:54272
    buffer_load_dwordx4 v[32:35], v5, s[12:15], s40 offen offset:256
    buffer_load_dwordx4 v[36:39], v5, s[12:15], s41 offen offset:256
    buffer_load_dwordx4 v[40:43], v5, s[12:15], s42 offen offset:256
    buffer_load_dwordx4 v[44:47], v5, s[12:15], s43 offen offset:256
    s_mov_b32 s44, 393216
    buffer_load_dwordx4 v[48:51], v7, s[16:19], s44 offen
    s_mov_b32 s44, 442368
    buffer_load_dwordx4 v[52:55], v7, s[16:19], s44 offen
    s_mov_b32 s44, 491520
    buffer_load_dwordx4 v[56:59], v7, s[16:19], s44 offen
    s_mov_b32 s44, 540672
    buffer_load_dwordx4 v[60:63], v7, s[16:19], s44 offen
    s_waitcnt lgkmcnt(0)
    s_barrier
    ds_read_b128 v[16:19], v9 offset:38912
    ds_read_b128 v[20:23], v9 offset:43520
    ds_read_b64_tr_b16 v[24:25], v11 offset:0
    ds_read_b64_tr_b16 v[26:27], v11 offset:1280
    ds_read_b64_tr_b16 v[28:29], v11 offset:64
    ds_read_b64_tr_b16 v[30:31], v11 offset:1344
    ds_read_b128 v[128:131], v9 offset:38944
    ds_read_b128 v[132:135], v9 offset:43552
    ds_read_b64_tr_b16 v[136:137], v11 offset:5120
    ds_read_b64_tr_b16 v[138:139], v11 offset:6400
    ds_read_b64_tr_b16 v[140:141], v11 offset:5184
    ds_read_b64_tr_b16 v[142:143], v11 offset:6464
    s_waitcnt lgkmcnt(6)
    v_mfma_f32_32x32x16_bf16 v[64:79], v[24:27], v[16:19], v[64:79]
    v_mfma_f32_32x32x16_bf16 v[80:95], v[28:31], v[16:19], v[80:95]
    v_mfma_f32_32x32x16_bf16 v[96:111], v[24:27], v[20:23], v[96:111]
    v_mfma_f32_32x32x16_bf16 v[112:127], v[28:31], v[20:23], v[112:127]
    ds_read_b128 v[16:19], v9 offset:38976
    ds_read_b128 v[20:23], v9 offset:43584
    ds_read_b64_tr_b16 v[24:25], v11 offset:10240
    ds_read_b64_tr_b16 v[26:27], v11 offset:11520
    ds_read_b64_tr_b16 v[28:29], v11 offset:10304
    ds_read_b64_tr_b16 v[30:31], v11 offset:11584
    s_waitcnt lgkmcnt(6)
    v_mfma_f32_32x32x16_bf16 v[64:79], v[136:139], v[128:131], v[64:79]
    v_mfma_f32_32x32x16_bf16 v[80:95], v[140:143], v[128:131], v[80:95]
    v_mfma_f32_32x32x16_bf16 v[96:111], v[136:139], v[132:135], v[96:111]
    v_mfma_f32_32x32x16_bf16 v[112:127], v[140:143], v[132:135], v[112:127]
    ds_read_b128 v[128:131], v9 offset:39008
    ds_read_b128 v[132:135], v9 offset:43616
    ds_read_b64_tr_b16 v[136:137], v11 offset:15360
    ds_read_b64_tr_b16 v[138:139], v11 offset:16640
    ds_read_b64_tr_b16 v[140:141], v11 offset:15424
    ds_read_b64_tr_b16 v[142:143], v11 offset:16704
    s_waitcnt lgkmcnt(6)
    v_mfma_f32_32x32x16_bf16 v[64:79], v[24:27], v[16:19], v[64:79]
    v_mfma_f32_32x32x16_bf16 v[80:95], v[28:31], v[16:19], v[80:95]
    v_mfma_f32_32x32x16_bf16 v[96:111], v[24:27], v[20:23], v[96:111]
    v_mfma_f32_32x32x16_bf16 v[112:127], v[28:31], v[20:23], v[112:127]
    s_waitcnt lgkmcnt(0)
    v_mfma_f32_32x32x16_bf16 v[64:79], v[136:139], v[128:131], v[64:79]
    v_mfma_f32_32x32x16_bf16 v[80:95], v[140:143], v[128:131], v[80:95]
    v_mfma_f32_32x32x16_bf16 v[96:111], v[136:139], v[132:135], v[96:111]
    v_mfma_f32_32x32x16_bf16 v[112:127], v[140:143], v[132:135], v[112:127]
    s_waitcnt vmcnt(0)
    ds_write_b128 v6, v[32:35] offset:0
    ds_write_b128 v6, v[36:39] offset:4608
    ds_write_b128 v6, v[40:43] offset:9216
    ds_write_b128 v6, v[44:47] offset:13824
    ds_write_b128 v8, v[48:51] offset:0
    ds_write_b128 v8, v[52:55] offset:5120
    ds_write_b128 v8, v[56:59] offset:10240
    ds_write_b128 v8, v[60:63] offset:15360
    buffer_load_dwordx4 v[32:35], v5, s[12:15], s40 offen offset:384
    buffer_load_dwordx4 v[36:39], v5, s[12:15], s41 offen offset:384
    buffer_load_dwordx4 v[40:43], v5, s[12:15], s42 offen offset:384
    buffer_load_dwordx4 v[44:47], v5, s[12:15], s43 offen offset:384
    s_mov_b32 s44, 589824
    buffer_load_dwordx4 v[48:51], v7, s[16:19], s44 offen
    s_mov_b32 s44, 638976
    buffer_load_dwordx4 v[52:55], v7, s[16:19], s44 offen
    s_mov_b32 s44, 688128
    buffer_load_dwordx4 v[56:59], v7, s[16:19], s44 offen
    s_mov_b32 s44, 737280
    buffer_load_dwordx4 v[60:63], v7, s[16:19], s44 offen
    s_waitcnt lgkmcnt(0)
    s_barrier
    ds_read_b128 v[16:19], v9 offset:0
    ds_read_b128 v[20:23], v9 offset:4608
    ds_read_b64_tr_b16 v[24:25], v10 offset:0
    ds_read_b64_tr_b16 v[26:27], v10 offset:1280
    ds_read_b64_tr_b16 v[28:29], v10 offset:64
    ds_read_b64_tr_b16 v[30:31], v10 offset:1344
    ds_read_b128 v[128:131], v9 offset:32
    ds_read_b128 v[132:135], v9 offset:4640
    ds_read_b64_tr_b16 v[136:137], v10 offset:5120
    ds_read_b64_tr_b16 v[138:139], v10 offset:6400
    ds_read_b64_tr_b16 v[140:141], v10 offset:5184
    ds_read_b64_tr_b16 v[142:143], v10 offset:6464
    s_waitcnt lgkmcnt(6)
    v_mfma_f32_32x32x16_bf16 v[64:79], v[24:27], v[16:19], v[64:79]
    v_mfma_f32_32x32x16_bf16 v[80:95], v[28:31], v[16:19], v[80:95]
    v_mfma_f32_32x32x16_bf16 v[96:111], v[24:27], v[20:23], v[96:111]
    v_mfma_f32_32x32x16_bf16 v[112:127], v[28:31], v[20:23], v[112:127]
    ds_read_b128 v[16:19], v9 offset:64
    ds_read_b128 v[20:23], v9 offset:4672
    ds_read_b64_tr_b16 v[24:25], v10 offset:10240
    ds_read_b64_tr_b16 v[26:27], v10 offset:11520
    ds_read_b64_tr_b16 v[28:29], v10 offset:10304
    ds_read_b64_tr_b16 v[30:31], v10 offset:11584
    s_waitcnt lgkmcnt(6)
    v_mfma_f32_32x32x16_bf16 v[64:79], v[136:139], v[128:131], v[64:79]
    v_mfma_f32_32x32x16_bf16 v[80:95], v[140:143], v[128:131], v[80:95]
    v_mfma_f32_32x32x16_bf16 v[96:111], v[136:139], v[132:135], v[96:111]
    v_mfma_f32_32x32x16_bf16 v[112:127], v[140:143], v[132:135], v[112:127]
    ds_read_b128 v[128:131], v9 offset:96
    ds_read_b128 v[132:135], v9 offset:4704
    ds_read_b64_tr_b16 v[136:137], v10 offset:15360
    ds_read_b64_tr_b16 v[138:139], v10 offset:16640
    ds_read_b64_tr_b16 v[140:141], v10 offset:15424
    ds_read_b64_tr_b16 v[142:143], v10 offset:16704
    s_waitcnt lgkmcnt(6)
    v_mfma_f32_32x32x16_bf16 v[64:79], v[24:27], v[16:19], v[64:79]
    v_mfma_f32_32x32x16_bf16 v[80:95], v[28:31], v[16:19], v[80:95]
    v_mfma_f32_32x32x16_bf16 v[96:111], v[24:27], v[20:23], v[96:111]
    v_mfma_f32_32x32x16_bf16 v[112:127], v[28:31], v[20:23], v[112:127]
    s_waitcnt lgkmcnt(0)
    v_mfma_f32_32x32x16_bf16 v[64:79], v[136:139], v[128:131], v[64:79]
    v_mfma_f32_32x32x16_bf16 v[80:95], v[140:143], v[128:131], v[80:95]
    v_mfma_f32_32x32x16_bf16 v[96:111], v[136:139], v[132:135], v[96:111]
    v_mfma_f32_32x32x16_bf16 v[112:127], v[140:143], v[132:135], v[112:127]
    s_waitcnt vmcnt(0)
    ds_write_b128 v6, v[32:35] offset:38912
    ds_write_b128 v6, v[36:39] offset:43520
    ds_write_b128 v6, v[40:43] offset:48128
    ds_write_b128 v6, v[44:47] offset:52736
    ds_write_b128 v8, v[48:51] offset:38912
    ds_write_b128 v8, v[52:55] offset:44032
    ds_write_b128 v8, v[56:59] offset:49152
    ds_write_b128 v8, v[60:63] offset:54272
    buffer_load_dwordx4 v[32:35], v5, s[12:15], s40 offen offset:512
    buffer_load_dwordx4 v[36:39], v5, s[12:15], s41 offen offset:512
    buffer_load_dwordx4 v[40:43], v5, s[12:15], s42 offen offset:512
    buffer_load_dwordx4 v[44:47], v5, s[12:15], s43 offen offset:512
    s_mov_b32 s44, 786432
    buffer_load_dwordx4 v[48:51], v7, s[16:19], s44 offen
    s_mov_b32 s44, 835584
    buffer_load_dwordx4 v[52:55], v7, s[16:19], s44 offen
    s_mov_b32 s44, 884736
    buffer_load_dwordx4 v[56:59], v7, s[16:19], s44 offen
    s_mov_b32 s44, 933888
    buffer_load_dwordx4 v[60:63], v7, s[16:19], s44 offen
    s_waitcnt lgkmcnt(0)
    s_barrier
    ds_read_b128 v[16:19], v9 offset:38912
    ds_read_b128 v[20:23], v9 offset:43520
    ds_read_b64_tr_b16 v[24:25], v11 offset:0
    ds_read_b64_tr_b16 v[26:27], v11 offset:1280
    ds_read_b64_tr_b16 v[28:29], v11 offset:64
    ds_read_b64_tr_b16 v[30:31], v11 offset:1344
    ds_read_b128 v[128:131], v9 offset:38944
    ds_read_b128 v[132:135], v9 offset:43552
    ds_read_b64_tr_b16 v[136:137], v11 offset:5120
    ds_read_b64_tr_b16 v[138:139], v11 offset:6400
    ds_read_b64_tr_b16 v[140:141], v11 offset:5184
    ds_read_b64_tr_b16 v[142:143], v11 offset:6464
    s_waitcnt lgkmcnt(6)
    v_mfma_f32_32x32x16_bf16 v[64:79], v[24:27], v[16:19], v[64:79]
    v_mfma_f32_32x32x16_bf16 v[80:95], v[28:31], v[16:19], v[80:95]
    v_mfma_f32_32x32x16_bf16 v[96:111], v[24:27], v[20:23], v[96:111]
    v_mfma_f32_32x32x16_bf16 v[112:127], v[28:31], v[20:23], v[112:127]
    ds_read_b128 v[16:19], v9 offset:38976
    ds_read_b128 v[20:23], v9 offset:43584
    ds_read_b64_tr_b16 v[24:25], v11 offset:10240
    ds_read_b64_tr_b16 v[26:27], v11 offset:11520
    ds_read_b64_tr_b16 v[28:29], v11 offset:10304
    ds_read_b64_tr_b16 v[30:31], v11 offset:11584
    s_waitcnt lgkmcnt(6)
    v_mfma_f32_32x32x16_bf16 v[64:79], v[136:139], v[128:131], v[64:79]
    v_mfma_f32_32x32x16_bf16 v[80:95], v[140:143], v[128:131], v[80:95]
    v_mfma_f32_32x32x16_bf16 v[96:111], v[136:139], v[132:135], v[96:111]
    v_mfma_f32_32x32x16_bf16 v[112:127], v[140:143], v[132:135], v[112:127]
    ds_read_b128 v[128:131], v9 offset:39008
    ds_read_b128 v[132:135], v9 offset:43616
    ds_read_b64_tr_b16 v[136:137], v11 offset:15360
    ds_read_b64_tr_b16 v[138:139], v11 offset:16640
    ds_read_b64_tr_b16 v[140:141], v11 offset:15424
    ds_read_b64_tr_b16 v[142:143], v11 offset:16704
    s_waitcnt lgkmcnt(6)
    v_mfma_f32_32x32x16_bf16 v[64:79], v[24:27], v[16:19], v[64:79]
    v_mfma_f32_32x32x16_bf16 v[80:95], v[28:31], v[16:19], v[80:95]
    v_mfma_f32_32x32x16_bf16 v[96:111], v[24:27], v[20:23], v[96:111]
    v_mfma_f32_32x32x16_bf16 v[112:127], v[28:31], v[20:23], v[112:127]
    s_waitcnt lgkmcnt(0)
    v_mfma_f32_32x32x16_bf16 v[64:79], v[136:139], v[128:131], v[64:79]
    v_mfma_f32_32x32x16_bf16 v[80:95], v[140:143], v[128:131], v[80:95]
    v_mfma_f32_32x32x16_bf16 v[96:111], v[136:139], v[132:135], v[96:111]
    v_mfma_f32_32x32x16_bf16 v[112:127], v[140:143], v[132:135], v[112:127]
    s_waitcnt vmcnt(0)
    ds_write_b128 v6, v[32:35] offset:0
    ds_write_b128 v6, v[36:39] offset:4608
    ds_write_b128 v6, v[40:43] offset:9216
    ds_write_b128 v6, v[44:47] offset:13824
    ds_write_b128 v8, v[48:51] offset:0
    ds_write_b128 v8, v[52:55] offset:5120
    ds_write_b128 v8, v[56:59] offset:10240
    ds_write_b128 v8, v[60:63] offset:15360
    buffer_load_dwordx4 v[32:35], v5, s[12:15], s40 offen offset:640
    buffer_load_dwordx4 v[36:39], v5, s[12:15], s41 offen offset:640
    buffer_load_dwordx4 v[40:43], v5, s[12:15], s42 offen offset:640
    buffer_load_dwordx4 v[44:47], v5, s[12:15], s43 offen offset:640
    s_mov_b32 s44, 983040
    buffer_load_dwordx4 v[48:51], v7, s[16:19], s44 offen
    s_mov_b32 s44, 1032192
    buffer_load_dwordx4 v[52:55], v7, s[16:19], s44 offen
    s_mov_b32 s44, 1081344
    buffer_load_dwordx4 v[56:59], v7, s[16:19], s44 offen
    s_mov_b32 s44, 1130496
    buffer_load_dwordx4 v[60:63], v7, s[16:19], s44 offen
    s_waitcnt lgkmcnt(0)
    s_barrier
    ds_read_b128 v[16:19], v9 offset:0
    ds_read_b128 v[20:23], v9 offset:4608
    ds_read_b64_tr_b16 v[24:25], v10 offset:0
    ds_read_b64_tr_b16 v[26:27], v10 offset:1280
    ds_read_b64_tr_b16 v[28:29], v10 offset:64
    ds_read_b64_tr_b16 v[30:31], v10 offset:1344
    ds_read_b128 v[128:131], v9 offset:32
    ds_read_b128 v[132:135], v9 offset:4640
    ds_read_b64_tr_b16 v[136:137], v10 offset:5120
    ds_read_b64_tr_b16 v[138:139], v10 offset:6400
    ds_read_b64_tr_b16 v[140:141], v10 offset:5184
    ds_read_b64_tr_b16 v[142:143], v10 offset:6464
    s_waitcnt lgkmcnt(6)
    v_mfma_f32_32x32x16_bf16 v[64:79], v[24:27], v[16:19], v[64:79]
    v_mfma_f32_32x32x16_bf16 v[80:95], v[28:31], v[16:19], v[80:95]
    v_mfma_f32_32x32x16_bf16 v[96:111], v[24:27], v[20:23], v[96:111]
    v_mfma_f32_32x32x16_bf16 v[112:127], v[28:31], v[20:23], v[112:127]
    ds_read_b128 v[16:19], v9 offset:64
    ds_read_b128 v[20:23], v9 offset:4672
    ds_read_b64_tr_b16 v[24:25], v10 offset:10240
    ds_read_b64_tr_b16 v[26:27], v10 offset:11520
    ds_read_b64_tr_b16 v[28:29], v10 offset:10304
    ds_read_b64_tr_b16 v[30:31], v10 offset:11584
    s_waitcnt lgkmcnt(6)
    v_mfma_f32_32x32x16_bf16 v[64:79], v[136:139], v[128:131], v[64:79]
    v_mfma_f32_32x32x16_bf16 v[80:95], v[140:143], v[128:131], v[80:95]
    v_mfma_f32_32x32x16_bf16 v[96:111], v[136:139], v[132:135], v[96:111]
    v_mfma_f32_32x32x16_bf16 v[112:127], v[140:143], v[132:135], v[112:127]
    ds_read_b128 v[128:131], v9 offset:96
    ds_read_b128 v[132:135], v9 offset:4704
    ds_read_b64_tr_b16 v[136:137], v10 offset:15360
    ds_read_b64_tr_b16 v[138:139], v10 offset:16640
    ds_read_b64_tr_b16 v[140:141], v10 offset:15424
    ds_read_b64_tr_b16 v[142:143], v10 offset:16704
    s_waitcnt lgkmcnt(6)
    v_mfma_f32_32x32x16_bf16 v[64:79], v[24:27], v[16:19], v[64:79]
    v_mfma_f32_32x32x16_bf16 v[80:95], v[28:31], v[16:19], v[80:95]
    v_mfma_f32_32x32x16_bf16 v[96:111], v[24:27], v[20:23], v[96:111]
    v_mfma_f32_32x32x16_bf16 v[112:127], v[28:31], v[20:23], v[112:127]
    s_waitcnt lgkmcnt(0)
    v_mfma_f32_32x32x16_bf16 v[64:79], v[136:139], v[128:131], v[64:79]
    v_mfma_f32_32x32x16_bf16 v[80:95], v[140:143], v[128:131], v[80:95]
    v_mfma_f32_32x32x16_bf16 v[96:111], v[136:139], v[132:135], v[96:111]
    v_mfma_f32_32x32x16_bf16 v[112:127], v[140:143], v[132:135], v[112:127]
    s_waitcnt vmcnt(0)
    ds_write_b128 v6, v[32:35] offset:38912
    ds_write_b128 v6, v[36:39] offset:43520
    ds_write_b128 v6, v[40:43] offset:48128
    ds_write_b128 v6, v[44:47] offset:52736
    ds_write_b128 v8, v[48:51] offset:38912
    ds_write_b128 v8, v[52:55] offset:44032
    ds_write_b128 v8, v[56:59] offset:49152
    ds_write_b128 v8, v[60:63] offset:54272
    buffer_load_dwordx4 v[32:35], v5, s[12:15], s40 offen offset:768
    buffer_load_dwordx4 v[36:39], v5, s[12:15], s41 offen offset:768
    buffer_load_dwordx4 v[40:43], v5, s[12:15], s42 offen offset:768
    buffer_load_dwordx4 v[44:47], v5, s[12:15], s43 offen offset:768
    s_mov_b32 s44, 1179648
    buffer_load_dwordx4 v[48:51], v7, s[16:19], s44 offen
    s_mov_b32 s44, 1228800
    buffer_load_dwordx4 v[52:55], v7, s[16:19], s44 offen
    s_mov_b32 s44, 1277952
    buffer_load_dwordx4 v[56:59], v7, s[16:19], s44 offen
    s_mov_b32 s44, 1327104
    buffer_load_dwordx4 v[60:63], v7, s[16:19], s44 offen
    s_waitcnt lgkmcnt(0)
    s_barrier
    ds_read_b128 v[16:19], v9 offset:38912
    ds_read_b128 v[20:23], v9 offset:43520
    ds_read_b64_tr_b16 v[24:25], v11 offset:0
    ds_read_b64_tr_b16 v[26:27], v11 offset:1280
    ds_read_b64_tr_b16 v[28:29], v11 offset:64
    ds_read_b64_tr_b16 v[30:31], v11 offset:1344
    ds_read_b128 v[128:131], v9 offset:38944
    ds_read_b128 v[132:135], v9 offset:43552
    ds_read_b64_tr_b16 v[136:137], v11 offset:5120
    ds_read_b64_tr_b16 v[138:139], v11 offset:6400
    ds_read_b64_tr_b16 v[140:141], v11 offset:5184
    ds_read_b64_tr_b16 v[142:143], v11 offset:6464
    s_waitcnt lgkmcnt(6)
    v_mfma_f32_32x32x16_bf16 v[64:79], v[24:27], v[16:19], v[64:79]
    v_mfma_f32_32x32x16_bf16 v[80:95], v[28:31], v[16:19], v[80:95]
    v_mfma_f32_32x32x16_bf16 v[96:111], v[24:27], v[20:23], v[96:111]
    v_mfma_f32_32x32x16_bf16 v[112:127], v[28:31], v[20:23], v[112:127]
    ds_read_b128 v[16:19], v9 offset:38976
    ds_read_b128 v[20:23], v9 offset:43584
    ds_read_b64_tr_b16 v[24:25], v11 offset:10240
    ds_read_b64_tr_b16 v[26:27], v11 offset:11520
    ds_read_b64_tr_b16 v[28:29], v11 offset:10304
    ds_read_b64_tr_b16 v[30:31], v11 offset:11584
    s_waitcnt lgkmcnt(6)
    v_mfma_f32_32x32x16_bf16 v[64:79], v[136:139], v[128:131], v[64:79]
    v_mfma_f32_32x32x16_bf16 v[80:95], v[140:143], v[128:131], v[80:95]
    v_mfma_f32_32x32x16_bf16 v[96:111], v[136:139], v[132:135], v[96:111]
    v_mfma_f32_32x32x16_bf16 v[112:127], v[140:143], v[132:135], v[112:127]
    ds_read_b128 v[128:131], v9 offset:39008
    ds_read_b128 v[132:135], v9 offset:43616
    ds_read_b64_tr_b16 v[136:137], v11 offset:15360
    ds_read_b64_tr_b16 v[138:139], v11 offset:16640
    ds_read_b64_tr_b16 v[140:141], v11 offset:15424
    ds_read_b64_tr_b16 v[142:143], v11 offset:16704
    s_waitcnt lgkmcnt(6)
    v_mfma_f32_32x32x16_bf16 v[64:79], v[24:27], v[16:19], v[64:79]
    v_mfma_f32_32x32x16_bf16 v[80:95], v[28:31], v[16:19], v[80:95]
    v_mfma_f32_32x32x16_bf16 v[96:111], v[24:27], v[20:23], v[96:111]
    v_mfma_f32_32x32x16_bf16 v[112:127], v[28:31], v[20:23], v[112:127]
    s_waitcnt lgkmcnt(0)
    v_mfma_f32_32x32x16_bf16 v[64:79], v[136:139], v[128:131], v[64:79]
    v_mfma_f32_32x32x16_bf16 v[80:95], v[140:143], v[128:131], v[80:95]
    v_mfma_f32_32x32x16_bf16 v[96:111], v[136:139], v[132:135], v[96:111]
    v_mfma_f32_32x32x16_bf16 v[112:127], v[140:143], v[132:135], v[112:127]
    s_waitcnt vmcnt(0)
    ds_write_b128 v6, v[32:35] offset:0
    ds_write_b128 v6, v[36:39] offset:4608
    ds_write_b128 v6, v[40:43] offset:9216
    ds_write_b128 v6, v[44:47] offset:13824
    ds_write_b128 v8, v[48:51] offset:0
    ds_write_b128 v8, v[52:55] offset:5120
    ds_write_b128 v8, v[56:59] offset:10240
    ds_write_b128 v8, v[60:63] offset:15360
    buffer_load_dwordx4 v[32:35], v5, s[12:15], s40 offen offset:896
    buffer_load_dwordx4 v[36:39], v5, s[12:15], s41 offen offset:896
    buffer_load_dwordx4 v[40:43], v5, s[12:15], s42 offen offset:896
    buffer_load_dwordx4 v[44:47], v5, s[12:15], s43 offen offset:896
    s_mov_b32 s44, 1376256
    buffer_load_dwordx4 v[48:51], v7, s[16:19], s44 offen
    s_mov_b32 s44, 1425408
    buffer_load_dwordx4 v[52:55], v7, s[16:19], s44 offen
    s_mov_b32 s44, 1474560
    buffer_load_dwordx4 v[56:59], v7, s[16:19], s44 offen
    s_mov_b32 s44, 1523712
    buffer_load_dwordx4 v[60:63], v7, s[16:19], s44 offen
    s_waitcnt lgkmcnt(0)
    s_barrier
    ds_read_b128 v[16:19], v9 offset:0
    ds_read_b128 v[20:23], v9 offset:4608
    ds_read_b64_tr_b16 v[24:25], v10 offset:0
    ds_read_b64_tr_b16 v[26:27], v10 offset:1280
    ds_read_b64_tr_b16 v[28:29], v10 offset:64
    ds_read_b64_tr_b16 v[30:31], v10 offset:1344
    ds_read_b128 v[128:131], v9 offset:32
    ds_read_b128 v[132:135], v9 offset:4640
    ds_read_b64_tr_b16 v[136:137], v10 offset:5120
    ds_read_b64_tr_b16 v[138:139], v10 offset:6400
    ds_read_b64_tr_b16 v[140:141], v10 offset:5184
    ds_read_b64_tr_b16 v[142:143], v10 offset:6464
    s_waitcnt lgkmcnt(6)
    v_mfma_f32_32x32x16_bf16 v[64:79], v[24:27], v[16:19], v[64:79]
    v_mfma_f32_32x32x16_bf16 v[80:95], v[28:31], v[16:19], v[80:95]
    v_mfma_f32_32x32x16_bf16 v[96:111], v[24:27], v[20:23], v[96:111]
    v_mfma_f32_32x32x16_bf16 v[112:127], v[28:31], v[20:23], v[112:127]
    ds_read_b128 v[16:19], v9 offset:64
    ds_read_b128 v[20:23], v9 offset:4672
    ds_read_b64_tr_b16 v[24:25], v10 offset:10240
    ds_read_b64_tr_b16 v[26:27], v10 offset:11520
    ds_read_b64_tr_b16 v[28:29], v10 offset:10304
    ds_read_b64_tr_b16 v[30:31], v10 offset:11584
    s_waitcnt lgkmcnt(6)
    v_mfma_f32_32x32x16_bf16 v[64:79], v[136:139], v[128:131], v[64:79]
    v_mfma_f32_32x32x16_bf16 v[80:95], v[140:143], v[128:131], v[80:95]
    v_mfma_f32_32x32x16_bf16 v[96:111], v[136:139], v[132:135], v[96:111]
    v_mfma_f32_32x32x16_bf16 v[112:127], v[140:143], v[132:135], v[112:127]
    ds_read_b128 v[128:131], v9 offset:96
    ds_read_b128 v[132:135], v9 offset:4704
    ds_read_b64_tr_b16 v[136:137], v10 offset:15360
    ds_read_b64_tr_b16 v[138:139], v10 offset:16640
    ds_read_b64_tr_b16 v[140:141], v10 offset:15424
    ds_read_b64_tr_b16 v[142:143], v10 offset:16704
    s_waitcnt lgkmcnt(6)
    v_mfma_f32_32x32x16_bf16 v[64:79], v[24:27], v[16:19], v[64:79]
    v_mfma_f32_32x32x16_bf16 v[80:95], v[28:31], v[16:19], v[80:95]
    v_mfma_f32_32x32x16_bf16 v[96:111], v[24:27], v[20:23], v[96:111]
    v_mfma_f32_32x32x16_bf16 v[112:127], v[28:31], v[20:23], v[112:127]
    s_waitcnt lgkmcnt(0)
    v_mfma_f32_32x32x16_bf16 v[64:79], v[136:139], v[128:131], v[64:79]
    v_mfma_f32_32x32x16_bf16 v[80:95], v[140:143], v[128:131], v[80:95]
    v_mfma_f32_32x32x16_bf16 v[96:111], v[136:139], v[132:135], v[96:111]
    v_mfma_f32_32x32x16_bf16 v[112:127], v[140:143], v[132:135], v[112:127]
    s_waitcnt vmcnt(0)
    ds_write_b128 v6, v[32:35] offset:38912
    ds_write_b128 v6, v[36:39] offset:43520
    ds_write_b128 v6, v[40:43] offset:48128
    ds_write_b128 v6, v[44:47] offset:52736
    ds_write_b128 v8, v[48:51] offset:38912
    ds_write_b128 v8, v[52:55] offset:44032
    ds_write_b128 v8, v[56:59] offset:49152
    ds_write_b128 v8, v[60:63] offset:54272
    s_waitcnt lgkmcnt(0)
    s_barrier
    ds_read_b128 v[16:19], v9 offset:38912
    ds_read_b128 v[20:23], v9 offset:43520
    ds_read_b64_tr_b16 v[24:25], v11 offset:0
    ds_read_b64_tr_b16 v[26:27], v11 offset:1280
    ds_read_b64_tr_b16 v[28:29], v11 offset:64
    ds_read_b64_tr_b16 v[30:31], v11 offset:1344
    ds_read_b128 v[128:131], v9 offset:38944
    ds_read_b128 v[132:135], v9 offset:43552
    ds_read_b64_tr_b16 v[136:137], v11 offset:5120
    ds_read_b64_tr_b16 v[138:139], v11 offset:6400
    ds_read_b64_tr_b16 v[140:141], v11 offset:5184
    ds_read_b64_tr_b16 v[142:143], v11 offset:6464
    s_waitcnt lgkmcnt(6)
    v_mfma_f32_32x32x16_bf16 v[64:79], v[24:27], v[16:19], v[64:79]
    v_mfma_f32_32x32x16_bf16 v[80:95], v[28:31], v[16:19], v[80:95]
    v_mfma_f32_32x32x16_bf16 v[96:111], v[24:27], v[20:23], v[96:111]
    v_mfma_f32_32x32x16_bf16 v[112:127], v[28:31], v[20:23], v[112:127]
    ds_read_b128 v[16:19], v9 offset:38976
    ds_read_b128 v[20:23], v9 offset:43584
    ds_read_b64_tr_b16 v[24:25], v11 offset:10240
    ds_read_b64_tr_b16 v[26:27], v11 offset:11520
    ds_read_b64_tr_b16 v[28:29], v11 offset:10304
    ds_read_b64_tr_b16 v[30:31], v11 offset:11584
    s_waitcnt lgkmcnt(6)
    v_mfma_f32_32x32x16_bf16 v[64:79], v[136:139], v[128:131], v[64:79]
    v_mfma_f32_32x32x16_bf16 v[80:95], v[140:143], v[128:131], v[80:95]
    v_mfma_f32_32x32x16_bf16 v[96:111], v[136:139], v[132:135], v[96:111]
    v_mfma_f32_32x32x16_bf16 v[112:127], v[140:143], v[132:135], v[112:127]
    ds_read_b128 v[128:131], v9 offset:39008
    ds_read_b128 v[132:135], v9 offset:43616
    ds_read_b64_tr_b16 v[136:137], v11 offset:15360
    ds_read_b64_tr_b16 v[138:139], v11 offset:16640
    ds_read_b64_tr_b16 v[140:141], v11 offset:15424
    ds_read_b64_tr_b16 v[142:143], v11 offset:16704
    s_waitcnt lgkmcnt(6)
    v_mfma_f32_32x32x16_bf16 v[64:79], v[24:27], v[16:19], v[64:79]
    v_mfma_f32_32x32x16_bf16 v[80:95], v[28:31], v[16:19], v[80:95]
    v_mfma_f32_32x32x16_bf16 v[96:111], v[24:27], v[20:23], v[96:111]
    v_mfma_f32_32x32x16_bf16 v[112:127], v[28:31], v[20:23], v[112:127]
    s_waitcnt lgkmcnt(0)
    v_mfma_f32_32x32x16_bf16 v[64:79], v[136:139], v[128:131], v[64:79]
    v_mfma_f32_32x32x16_bf16 v[80:95], v[140:143], v[128:131], v[80:95]
    v_mfma_f32_32x32x16_bf16 v[96:111], v[136:139], v[132:135], v[96:111]
    v_mfma_f32_32x32x16_bf16 v[112:127], v[140:143], v[132:135], v[112:127]
    s_nop 7
    s_nop 7
    s_cmp_eq_u32 s30, 0
    s_cselect_b32 s36, 0x3eb8aa3b, 1.0
    s_cselect_b32 s37, 0, 4194304
    s_lshl_b32 s38, s26, 21
    s_add_u32 s37, s37, s38
    v_and_b32 v3, 31, v1
    v_lshrrev_b32 v4, 5, v1
    v_lshlrev_b32 v3, 4, v3
    v_lshl_add_u32 v3, v4, 9, v3
    v_mul_f32 v64, s36, v64
    v_mul_f32 v65, s36, v65
    v_mul_f32 v66, s36, v66
    v_mul_f32 v67, s36, v67
    v_mul_f32 v68, s36, v68
    v_mul_f32 v69, s36, v69
    v_mul_f32 v70, s36, v70
    v_mul_f32 v71, s36, v71
    v_mul_f32 v72, s36, v72
    v_mul_f32 v73, s36, v73
    v_mul_f32 v74, s36, v74
    v_mul_f32 v75, s36, v75
    v_mul_f32 v76, s36, v76
    v_mul_f32 v77, s36, v77
    v_mul_f32 v78, s36, v78
    v_mul_f32 v79, s36, v79
    v_cvt_pk_bf16_f32 v32, v64, v65
    v_cvt_pk_bf16_f32 v33, v66, v67
    v_cvt_pk_bf16_f32 v34, v68, v69
    v_cvt_pk_bf16_f32 v35, v70, v71
    s_lshl_b32 s38, s31, 3
    s_lshl_b32 s39, s34, 2
    s_add_u32 s38, s38, s39
    s_add_u32 s38, s38, 0
    s_lshl_b32 s38, s38, 6
    s_lshl_b32 s39, s29, 2
    s_add_u32 s38, s38, s39
    s_lshl_b32 s39, s33, 1
    s_add_u32 s38, s38, s39
    s_add_u32 s38, s38, 0
    s_lshl_b32 s38, s38, 10
    s_add_u32 s38, s38, s37
    buffer_store_dwordx4 v[32:35], v3, s[20:23], s38 offen
    v_cvt_pk_bf16_f32 v36, v72, v73
    v_cvt_pk_bf16_f32 v37, v74, v75
    v_cvt_pk_bf16_f32 v38, v76, v77
    v_cvt_pk_bf16_f32 v39, v78, v79
    s_lshl_b32 s38, s31, 3
    s_lshl_b32 s39, s34, 2
    s_add_u32 s38, s38, s39
    s_add_u32 s38, s38, 1
    s_lshl_b32 s38, s38, 6
    s_lshl_b32 s39, s29, 2
    s_add_u32 s38, s38, s39
    s_lshl_b32 s39, s33, 1
    s_add_u32 s38, s38, s39
    s_add_u32 s38, s38, 0
    s_lshl_b32 s38, s38, 10
    s_add_u32 s38, s38, s37
    buffer_store_dwordx4 v[36:39], v3, s[20:23], s38 offen
    v_mul_f32 v80, s36, v80
    v_mul_f32 v81, s36, v81
    v_mul_f32 v82, s36, v82
    v_mul_f32 v83, s36, v83
    v_mul_f32 v84, s36, v84
    v_mul_f32 v85, s36, v85
    v_mul_f32 v86, s36, v86
    v_mul_f32 v87, s36, v87
    v_mul_f32 v88, s36, v88
    v_mul_f32 v89, s36, v89
    v_mul_f32 v90, s36, v90
    v_mul_f32 v91, s36, v91
    v_mul_f32 v92, s36, v92
    v_mul_f32 v93, s36, v93
    v_mul_f32 v94, s36, v94
    v_mul_f32 v95, s36, v95
    v_cvt_pk_bf16_f32 v40, v80, v81
    v_cvt_pk_bf16_f32 v41, v82, v83
    v_cvt_pk_bf16_f32 v42, v84, v85
    v_cvt_pk_bf16_f32 v43, v86, v87
    s_lshl_b32 s38, s31, 3
    s_lshl_b32 s39, s34, 2
    s_add_u32 s38, s38, s39
    s_add_u32 s38, s38, 2
    s_lshl_b32 s38, s38, 6
    s_lshl_b32 s39, s29, 2
    s_add_u32 s38, s38, s39
    s_lshl_b32 s39, s33, 1
    s_add_u32 s38, s38, s39
    s_add_u32 s38, s38, 0
    s_lshl_b32 s38, s38, 10
    s_add_u32 s38, s38, s37
    buffer_store_dwordx4 v[40:43], v3, s[20:23], s38 offen
    v_cvt_pk_bf16_f32 v44, v88, v89
    v_cvt_pk_bf16_f32 v45, v90, v91
    v_cvt_pk_bf16_f32 v46, v92, v93
    v_cvt_pk_bf16_f32 v47, v94, v95
    s_lshl_b32 s38, s31, 3
    s_lshl_b32 s39, s34, 2
    s_add_u32 s38, s38, s39
    s_add_u32 s38, s38, 3
    s_lshl_b32 s38, s38, 6
    s_lshl_b32 s39, s29, 2
    s_add_u32 s38, s38, s39
    s_lshl_b32 s39, s33, 1
    s_add_u32 s38, s38, s39
    s_add_u32 s38, s38, 0
    s_lshl_b32 s38, s38, 10
    s_add_u32 s38, s38, s37
    buffer_store_dwordx4 v[44:47], v3, s[20:23], s38 offen
    v_mul_f32 v96, s36, v96
    v_mul_f32 v97, s36, v97
    v_mul_f32 v98, s36, v98
    v_mul_f32 v99, s36, v99
    v_mul_f32 v100, s36, v100
    v_mul_f32 v101, s36, v101
    v_mul_f32 v102, s36, v102
    v_mul_f32 v103, s36, v103
    v_mul_f32 v104, s36, v104
    v_mul_f32 v105, s36, v105
    v_mul_f32 v106, s36, v106
    v_mul_f32 v107, s36, v107
    v_mul_f32 v108, s36, v108
    v_mul_f32 v109, s36, v109
    v_mul_f32 v110, s36, v110
    v_mul_f32 v111, s36, v111
    v_cvt_pk_bf16_f32 v48, v96, v97
    v_cvt_pk_bf16_f32 v49, v98, v99
    v_cvt_pk_bf16_f32 v50, v100, v101
    v_cvt_pk_bf16_f32 v51, v102, v103
    s_lshl_b32 s38, s31, 3
    s_lshl_b32 s39, s34, 2
    s_add_u32 s38, s38, s39
    s_add_u32 s38, s38, 0
    s_lshl_b32 s38, s38, 6
    s_lshl_b32 s39, s29, 2
    s_add_u32 s38, s38, s39
    s_lshl_b32 s39, s33, 1
    s_add_u32 s38, s38, s39
    s_add_u32 s38, s38, 1
    s_lshl_b32 s38, s38, 10
    s_add_u32 s38, s38, s37
    buffer_store_dwordx4 v[48:51], v3, s[20:23], s38 offen
    v_cvt_pk_bf16_f32 v52, v104, v105
    v_cvt_pk_bf16_f32 v53, v106, v107
    v_cvt_pk_bf16_f32 v54, v108, v109
    v_cvt_pk_bf16_f32 v55, v110, v111
    s_lshl_b32 s38, s31, 3
    s_lshl_b32 s39, s34, 2
    s_add_u32 s38, s38, s39
    s_add_u32 s38, s38, 1
    s_lshl_b32 s38, s38, 6
    s_lshl_b32 s39, s29, 2
    s_add_u32 s38, s38, s39
    s_lshl_b32 s39, s33, 1
    s_add_u32 s38, s38, s39
    s_add_u32 s38, s38, 1
    s_lshl_b32 s38, s38, 10
    s_add_u32 s38, s38, s37
    buffer_store_dwordx4 v[52:55], v3, s[20:23], s38 offen
    v_mul_f32 v112, s36, v112
    v_mul_f32 v113, s36, v113
    v_mul_f32 v114, s36, v114
    v_mul_f32 v115, s36, v115
    v_mul_f32 v116, s36, v116
    v_mul_f32 v117, s36, v117
    v_mul_f32 v118, s36, v118
    v_mul_f32 v119, s36, v119
    v_mul_f32 v120, s36, v120
    v_mul_f32 v121, s36, v121
    v_mul_f32 v122, s36, v122
    v_mul_f32 v123, s36, v123
    v_mul_f32 v124, s36, v124
    v_mul_f32 v125, s36, v125
    v_mul_f32 v126, s36, v126
    v_mul_f32 v127, s36, v127
    v_cvt_pk_bf16_f32 v56, v112, v113
    v_cvt_pk_bf16_f32 v57, v114, v115
    v_cvt_pk_bf16_f32 v58, v116, v117
    v_cvt_pk_bf16_f32 v59, v118, v119
    s_lshl_b32 s38, s31, 3
    s_lshl_b32 s39, s34, 2
    s_add_u32 s38, s38, s39
    s_add_u32 s38, s38, 2
    s_lshl_b32 s38, s38, 6
    s_lshl_b32 s39, s29, 2
    s_add_u32 s38, s38, s39
    s_lshl_b32 s39, s33, 1
    s_add_u32 s38, s38, s39
    s_add_u32 s38, s38, 1
    s_lshl_b32 s38, s38, 10
    s_add_u32 s38, s38, s37
    buffer_store_dwordx4 v[56:59], v3, s[20:23], s38 offen
    v_cvt_pk_bf16_f32 v60, v120, v121
    v_cvt_pk_bf16_f32 v61, v122, v123
    v_cvt_pk_bf16_f32 v62, v124, v125
    v_cvt_pk_bf16_f32 v63, v126, v127
    s_lshl_b32 s38, s31, 3
    s_lshl_b32 s39, s34, 2
    s_add_u32 s38, s38, s39
    s_add_u32 s38, s38, 3
    s_lshl_b32 s38, s38, 6
    s_lshl_b32 s39, s29, 2
    s_add_u32 s38, s38, s39
    s_lshl_b32 s39, s33, 1
    s_add_u32 s38, s38, s39
    s_add_u32 s38, s38, 1
    s_lshl_b32 s38, s38, 10
    s_add_u32 s38, s38, s37
    buffer_store_dwordx4 v[60:63], v3, s[20:23], s38 offen
    s_branch L_qkv_done
L_qkv_vpath:
    buffer_load_dwordx4 v[32:35], v5, s[12:15], s40 offen offset:0
    buffer_load_dwordx4 v[36:39], v5, s[12:15], s41 offen offset:0
    buffer_load_dwordx4 v[40:43], v5, s[12:15], s42 offen offset:0
    buffer_load_dwordx4 v[44:47], v5, s[12:15], s43 offen offset:0
    s_mov_b32 s44, 0
    buffer_load_dwordx4 v[48:51], v7, s[16:19], s44 offen
    s_mov_b32 s44, 49152
    buffer_load_dwordx4 v[52:55], v7, s[16:19], s44 offen
    s_mov_b32 s44, 98304
    buffer_load_dwordx4 v[56:59], v7, s[16:19], s44 offen
    s_mov_b32 s44, 147456
    buffer_load_dwordx4 v[60:63], v7, s[16:19], s44 offen
    s_waitcnt vmcnt(0)
    ds_write_b128 v6, v[32:35] offset:0
    ds_write_b128 v6, v[36:39] offset:4608
    ds_write_b128 v6, v[40:43] offset:9216
    ds_write_b128 v6, v[44:47] offset:13824
    ds_write_b128 v8, v[48:51] offset:0
    ds_write_b128 v8, v[52:55] offset:5120
    ds_write_b128 v8, v[56:59] offset:10240
    ds_write_b128 v8, v[60:63] offset:15360
    buffer_load_dwordx4 v[32:35], v5, s[12:15], s40 offen offset:128
    buffer_load_dwordx4 v[36:39], v5, s[12:15], s41 offen offset:128
    buffer_load_dwordx4 v[40:43], v5, s[12:15], s42 offen offset:128
    buffer_load_dwordx4 v[44:47], v5, s[12:15], s43 offen offset:128
    s_mov_b32 s44, 196608
    buffer_load_dwordx4 v[48:51], v7, s[16:19], s44 offen
    s_mov_b32 s44, 245760
    buffer_load_dwordx4 v[52:55], v7, s[16:19], s44 offen
    s_mov_b32 s44, 294912
    buffer_load_dwordx4 v[56:59], v7, s[16:19], s44 offen
    s_mov_b32 s44, 344064
    buffer_load_dwordx4 v[60:63], v7, s[16:19], s44 offen
    s_waitcnt lgkmcnt(0)
    s_barrier
    ds_read_b128 v[16:19], v9 offset:0
    ds_read_b128 v[20:23], v9 offset:4608
    ds_read_b64_tr_b16 v[24:25], v10 offset:0
    ds_read_b64_tr_b16 v[26:27], v10 offset:1280
    ds_read_b64_tr_b16 v[28:29], v10 offset:64
    ds_read_b64_tr_b16 v[30:31], v10 offset:1344
    ds_read_b128 v[128:131], v9 offset:32
    ds_read_b128 v[132:135], v9 offset:4640
    ds_read_b64_tr_b16 v[136:137], v10 offset:5120
    ds_read_b64_tr_b16 v[138:139], v10 offset:6400
    ds_read_b64_tr_b16 v[140:141], v10 offset:5184
    ds_read_b64_tr_b16 v[142:143], v10 offset:6464
    s_waitcnt lgkmcnt(6)
    v_mfma_f32_32x32x16_bf16 v[64:79], v[16:19], v[24:27], v[64:79]
    v_mfma_f32_32x32x16_bf16 v[80:95], v[16:19], v[28:31], v[80:95]
    v_mfma_f32_32x32x16_bf16 v[96:111], v[20:23], v[24:27], v[96:111]
    v_mfma_f32_32x32x16_bf16 v[112:127], v[20:23], v[28:31], v[112:127]
    ds_read_b128 v[16:19], v9 offset:64
    ds_read_b128 v[20:23], v9 offset:4672
    ds_read_b64_tr_b16 v[24:25], v10 offset:10240
    ds_read_b64_tr_b16 v[26:27], v10 offset:11520
    ds_read_b64_tr_b16 v[28:29], v10 offset:10304
    ds_read_b64_tr_b16 v[30:31], v10 offset:11584
    s_waitcnt lgkmcnt(6)
    v_mfma_f32_32x32x16_bf16 v[64:79], v[128:131], v[136:139], v[64:79]
    v_mfma_f32_32x32x16_bf16 v[80:95], v[128:131], v[140:143], v[80:95]
    v_mfma_f32_32x32x16_bf16 v[96:111], v[132:135], v[136:139], v[96:111]
    v_mfma_f32_32x32x16_bf16 v[112:127], v[132:135], v[140:143], v[112:127]
    ds_read_b128 v[128:131], v9 offset:96
    ds_read_b128 v[132:135], v9 offset:4704
    ds_read_b64_tr_b16 v[136:137], v10 offset:15360
    ds_read_b64_tr_b16 v[138:139], v10 offset:16640
    ds_read_b64_tr_b16 v[140:141], v10 offset:15424
    ds_read_b64_tr_b16 v[142:143], v10 offset:16704
    s_waitcnt lgkmcnt(6)
    v_mfma_f32_32x32x16_bf16 v[64:79], v[16:19], v[24:27], v[64:79]
    v_mfma_f32_32x32x16_bf16 v[80:95], v[16:19], v[28:31], v[80:95]
    v_mfma_f32_32x32x16_bf16 v[96:111], v[20:23], v[24:27], v[96:111]
    v_mfma_f32_32x32x16_bf16 v[112:127], v[20:23], v[28:31], v[112:127]
    s_waitcnt lgkmcnt(0)
    v_mfma_f32_32x32x16_bf16 v[64:79], v[128:131], v[136:139], v[64:79]
    v_mfma_f32_32x32x16_bf16 v[80:95], v[128:131], v[140:143], v[80:95]
    v_mfma_f32_32x32x16_bf16 v[96:111], v[132:135], v[136:139], v[96:111]
    v_mfma_f32_32x32x16_bf16 v[112:127], v[132:135], v[140:143], v[112:127]
    s_waitcnt vmcnt(0)
    ds_write_b128 v6, v[32:35] offset:38912
    ds_write_b128 v6, v[36:39] offset:43520
    ds_write_b128 v6, v[40:43] offset:48128
    ds_write_b128 v6, v[44:47] offset:52736
    ds_write_b128 v8, v[48:51] offset:38912
    ds_write_b128 v8, v[52:55] offset:44032
    ds_write_b128 v8, v[56:59] offset:49152
    ds_write_b128 v8, v[60:63] offset:54272
    buffer_load_dwordx4 v[32:35], v5, s[12:15], s40 offen offset:256
    buffer_load_dwordx4 v[36:39], v5, s[12:15], s41 offen offset:256
    buffer_load_dwordx4 v[40:43], v5, s[12:15], s42 offen offset:256
    buffer_load_dwordx4 v[44:47], v5, s[12:15], s43 offen offset:256
    s_mov_b32 s44, 393216
    buffer_load_dwordx4 v[48:51], v7, s[16:19], s44 offen
    s_mov_b32 s44, 442368
    buffer_load_dwordx4 v[52:55], v7, s[16:19], s44 offen
    s_mov_b32 s44, 491520
    buffer_load_dwordx4 v[56:59], v7, s[16:19], s44 offen
    s_mov_b32 s44, 540672
    buffer_load_dwordx4 v[60:63], v7, s[16:19], s44 offen
    s_waitcnt lgkmcnt(0)
    s_barrier
    ds_read_b128 v[16:19], v9 offset:38912
    ds_read_b128 v[20:23], v9 offset:43520
    ds_read_b64_tr_b16 v[24:25], v11 offset:0
    ds_read_b64_tr_b16 v[26:27], v11 offset:1280
    ds_read_b64_tr_b16 v[28:29], v11 offset:64
    ds_read_b64_tr_b16 v[30:31], v11 offset:1344
    ds_read_b128 v[128:131], v9 offset:38944
    ds_read_b128 v[132:135], v9 offset:43552
    ds_read_b64_tr_b16 v[136:137], v11 offset:5120
    ds_read_b64_tr_b16 v[138:139], v11 offset:6400
    ds_read_b64_tr_b16 v[140:141], v11 offset:5184
    ds_read_b64_tr_b16 v[142:143], v11 offset:6464
    s_waitcnt lgkmcnt(6)
    v_mfma_f32_32x32x16_bf16 v[64:79], v[16:19], v[24:27], v[64:79]
    v_mfma_f32_32x32x16_bf16 v[80:95], v[16:19], v[28:31], v[80:95]
    v_mfma_f32_32x32x16_bf16 v[96:111], v[20:23], v[24:27], v[96:111]
    v_mfma_f32_32x32x16_bf16 v[112:127], v[20:23], v[28:31], v[112:127]
    ds_read_b128 v[16:19], v9 offset:38976
    ds_read_b128 v[20:23], v9 offset:43584
    ds_read_b64_tr_b16 v[24:25], v11 offset:10240
    ds_read_b64_tr_b16 v[26:27], v11 offset:11520
    ds_read_b64_tr_b16 v[28:29], v11 offset:10304
    ds_read_b64_tr_b16 v[30:31], v11 offset:11584
    s_waitcnt lgkmcnt(6)
    v_mfma_f32_32x32x16_bf16 v[64:79], v[128:131], v[136:139], v[64:79]
    v_mfma_f32_32x32x16_bf16 v[80:95], v[128:131], v[140:143], v[80:95]
    v_mfma_f32_32x32x16_bf16 v[96:111], v[132:135], v[136:139], v[96:111]
    v_mfma_f32_32x32x16_bf16 v[112:127], v[132:135], v[140:143], v[112:127]
    ds_read_b128 v[128:131], v9 offset:39008
    ds_read_b128 v[132:135], v9 offset:43616
    ds_read_b64_tr_b16 v[136:137], v11 offset:15360
    ds_read_b64_tr_b16 v[138:139], v11 offset:16640
    ds_read_b64_tr_b16 v[140:141], v11 offset:15424
    ds_read_b64_tr_b16 v[142:143], v11 offset:16704
    s_waitcnt lgkmcnt(6)
    v_mfma_f32_32x32x16_bf16 v[64:79], v[16:19], v[24:27], v[64:79]
    v_mfma_f32_32x32x16_bf16 v[80:95], v[16:19], v[28:31], v[80:95]
    v_mfma_f32_32x32x16_bf16 v[96:111], v[20:23], v[24:27], v[96:111]
    v_mfma_f32_32x32x16_bf16 v[112:127], v[20:23], v[28:31], v[112:127]
    s_waitcnt lgkmcnt(0)
    v_mfma_f32_32x32x16_bf16 v[64:79], v[128:131], v[136:139], v[64:79]
    v_mfma_f32_32x32x16_bf16 v[80:95], v[128:131], v[140:143], v[80:95]
    v_mfma_f32_32x32x16_bf16 v[96:111], v[132:135], v[136:139], v[96:111]
    v_mfma_f32_32x32x16_bf16 v[112:127], v[132:135], v[140:143], v[112:127]
    s_waitcnt vmcnt(0)
    ds_write_b128 v6, v[32:35] offset:0
    ds_write_b128 v6, v[36:39] offset:4608
    ds_write_b128 v6, v[40:43] offset:9216
    ds_write_b128 v6, v[44:47] offset:13824
    ds_write_b128 v8, v[48:51] offset:0
    ds_write_b128 v8, v[52:55] offset:5120
    ds_write_b128 v8, v[56:59] offset:10240
    ds_write_b128 v8, v[60:63] offset:15360
    buffer_load_dwordx4 v[32:35], v5, s[12:15], s40 offen offset:384
    buffer_load_dwordx4 v[36:39], v5, s[12:15], s41 offen offset:384
    buffer_load_dwordx4 v[40:43], v5, s[12:15], s42 offen offset:384
    buffer_load_dwordx4 v[44:47], v5, s[12:15], s43 offen offset:384
    s_mov_b32 s44, 589824
    buffer_load_dwordx4 v[48:51], v7, s[16:19], s44 offen
    s_mov_b32 s44, 638976
    buffer_load_dwordx4 v[52:55], v7, s[16:19], s44 offen
    s_mov_b32 s44, 688128
    buffer_load_dwordx4 v[56:59], v7, s[16:19], s44 offen
    s_mov_b32 s44, 737280
    buffer_load_dwordx4 v[60:63], v7, s[16:19], s44 offen
    s_waitcnt lgkmcnt(0)
    s_barrier
    ds_read_b128 v[16:19], v9 offset:0
    ds_read_b128 v[20:23], v9 offset:4608
    ds_read_b64_tr_b16 v[24:25], v10 offset:0
    ds_read_b64_tr_b16 v[26:27], v10 offset:1280
    ds_read_b64_tr_b16 v[28:29], v10 offset:64
    ds_read_b64_tr_b16 v[30:31], v10 offset:1344
    ds_read_b128 v[128:131], v9 offset:32
    ds_read_b128 v[132:135], v9 offset:4640
    ds_read_b64_tr_b16 v[136:137], v10 offset:5120
    ds_read_b64_tr_b16 v[138:139], v10 offset:6400
    ds_read_b64_tr_b16 v[140:141], v10 offset:5184
    ds_read_b64_tr_b16 v[142:143], v10 offset:6464
    s_waitcnt lgkmcnt(6)
    v_mfma_f32_32x32x16_bf16 v[64:79], v[16:19], v[24:27], v[64:79]
    v_mfma_f32_32x32x16_bf16 v[80:95], v[16:19], v[28:31], v[80:95]
    v_mfma_f32_32x32x16_bf16 v[96:111], v[20:23], v[24:27], v[96:111]
    v_mfma_f32_32x32x16_bf16 v[112:127], v[20:23], v[28:31], v[112:127]
    ds_read_b128 v[16:19], v9 offset:64
    ds_read_b128 v[20:23], v9 offset:4672
    ds_read_b64_tr_b16 v[24:25], v10 offset:10240
    ds_read_b64_tr_b16 v[26:27], v10 offset:11520
    ds_read_b64_tr_b16 v[28:29], v10 offset:10304
    ds_read_b64_tr_b16 v[30:31], v10 offset:11584
    s_waitcnt lgkmcnt(6)
    v_mfma_f32_32x32x16_bf16 v[64:79], v[128:131], v[136:139], v[64:79]
    v_mfma_f32_32x32x16_bf16 v[80:95], v[128:131], v[140:143], v[80:95]
    v_mfma_f32_32x32x16_bf16 v[96:111], v[132:135], v[136:139], v[96:111]
    v_mfma_f32_32x32x16_bf16 v[112:127], v[132:135], v[140:143], v[112:127]
    ds_read_b128 v[128:131], v9 offset:96
    ds_read_b128 v[132:135], v9 offset:4704
    ds_read_b64_tr_b16 v[136:137], v10 offset:15360
    ds_read_b64_tr_b16 v[138:139], v10 offset:16640
    ds_read_b64_tr_b16 v[140:141], v10 offset:15424
    ds_read_b64_tr_b16 v[142:143], v10 offset:16704
    s_waitcnt lgkmcnt(6)
    v_mfma_f32_32x32x16_bf16 v[64:79], v[16:19], v[24:27], v[64:79]
    v_mfma_f32_32x32x16_bf16 v[80:95], v[16:19], v[28:31], v[80:95]
    v_mfma_f32_32x32x16_bf16 v[96:111], v[20:23], v[24:27], v[96:111]
    v_mfma_f32_32x32x16_bf16 v[112:127], v[20:23], v[28:31], v[112:127]
    s_waitcnt lgkmcnt(0)
    v_mfma_f32_32x32x16_bf16 v[64:79], v[128:131], v[136:139], v[64:79]
    v_mfma_f32_32x32x16_bf16 v[80:95], v[128:131], v[140:143], v[80:95]
    v_mfma_f32_32x32x16_bf16 v[96:111], v[132:135], v[136:139], v[96:111]
    v_mfma_f32_32x32x16_bf16 v[112:127], v[132:135], v[140:143], v[112:127]
    s_waitcnt vmcnt(0)
    ds_write_b128 v6, v[32:35] offset:38912
    ds_write_b128 v6, v[36:39] offset:43520
    ds_write_b128 v6, v[40:43] offset:48128
    ds_write_b128 v6, v[44:47] offset:52736
    ds_write_b128 v8, v[48:51] offset:38912
    ds_write_b128 v8, v[52:55] offset:44032
    ds_write_b128 v8, v[56:59] offset:49152
    ds_write_b128 v8, v[60:63] offset:54272
    buffer_load_dwordx4 v[32:35], v5, s[12:15], s40 offen offset:512
    buffer_load_dwordx4 v[36:39], v5, s[12:15], s41 offen offset:512
    buffer_load_dwordx4 v[40:43], v5, s[12:15], s42 offen offset:512
    buffer_load_dwordx4 v[44:47], v5, s[12:15], s43 offen offset:512
    s_mov_b32 s44, 786432
    buffer_load_dwordx4 v[48:51], v7, s[16:19], s44 offen
    s_mov_b32 s44, 835584
    buffer_load_dwordx4 v[52:55], v7, s[16:19], s44 offen
    s_mov_b32 s44, 884736
    buffer_load_dwordx4 v[56:59], v7, s[16:19], s44 offen
    s_mov_b32 s44, 933888
    buffer_load_dwordx4 v[60:63], v7, s[16:19], s44 offen
    s_waitcnt lgkmcnt(0)
    s_barrier
    ds_read_b128 v[16:19], v9 offset:38912
    ds_read_b128 v[20:23], v9 offset:43520
    ds_read_b64_tr_b16 v[24:25], v11 offset:0
    ds_read_b64_tr_b16 v[26:27], v11 offset:1280
    ds_read_b64_tr_b16 v[28:29], v11 offset:64
    ds_read_b64_tr_b16 v[30:31], v11 offset:1344
    ds_read_b128 v[128:131], v9 offset:38944
    ds_read_b128 v[132:135], v9 offset:43552
    ds_read_b64_tr_b16 v[136:137], v11 offset:5120
    ds_read_b64_tr_b16 v[138:139], v11 offset:6400
    ds_read_b64_tr_b16 v[140:141], v11 offset:5184
    ds_read_b64_tr_b16 v[142:143], v11 offset:6464
    s_waitcnt lgkmcnt(6)
    v_mfma_f32_32x32x16_bf16 v[64:79], v[16:19], v[24:27], v[64:79]
    v_mfma_f32_32x32x16_bf16 v[80:95], v[16:19], v[28:31], v[80:95]
    v_mfma_f32_32x32x16_bf16 v[96:111], v[20:23], v[24:27], v[96:111]
    v_mfma_f32_32x32x16_bf16 v[112:127], v[20:23], v[28:31], v[112:127]
    ds_read_b128 v[16:19], v9 offset:38976
    ds_read_b128 v[20:23], v9 offset:43584
    ds_read_b64_tr_b16 v[24:25], v11 offset:10240
    ds_read_b64_tr_b16 v[26:27], v11 offset:11520
    ds_read_b64_tr_b16 v[28:29], v11 offset:10304
    ds_read_b64_tr_b16 v[30:31], v11 offset:11584
    s_waitcnt lgkmcnt(6)
    v_mfma_f32_32x32x16_bf16 v[64:79], v[128:131], v[136:139], v[64:79]
    v_mfma_f32_32x32x16_bf16 v[80:95], v[128:131], v[140:143], v[80:95]
    v_mfma_f32_32x32x16_bf16 v[96:111], v[132:135], v[136:139], v[96:111]
    v_mfma_f32_32x32x16_bf16 v[112:127], v[132:135], v[140:143], v[112:127]
    ds_read_b128 v[128:131], v9 offset:39008
    ds_read_b128 v[132:135], v9 offset:43616
    ds_read_b64_tr_b16 v[136:137], v11 offset:15360
    ds_read_b64_tr_b16 v[138:139], v11 offset:16640
    ds_read_b64_tr_b16 v[140:141], v11 offset:15424
    ds_read_b64_tr_b16 v[142:143], v11 offset:16704
    s_waitcnt lgkmcnt(6)
    v_mfma_f32_32x32x16_bf16 v[64:79], v[16:19], v[24:27], v[64:79]
    v_mfma_f32_32x32x16_bf16 v[80:95], v[16:19], v[28:31], v[80:95]
    v_mfma_f32_32x32x16_bf16 v[96:111], v[20:23], v[24:27], v[96:111]
    v_mfma_f32_32x32x16_bf16 v[112:127], v[20:23], v[28:31], v[112:127]
    s_waitcnt lgkmcnt(0)
    v_mfma_f32_32x32x16_bf16 v[64:79], v[128:131], v[136:139], v[64:79]
    v_mfma_f32_32x32x16_bf16 v[80:95], v[128:131], v[140:143], v[80:95]
    v_mfma_f32_32x32x16_bf16 v[96:111], v[132:135], v[136:139], v[96:111]
    v_mfma_f32_32x32x16_bf16 v[112:127], v[132:135], v[140:143], v[112:127]
    s_waitcnt vmcnt(0)
    ds_write_b128 v6, v[32:35] offset:0
    ds_write_b128 v6, v[36:39] offset:4608
    ds_write_b128 v6, v[40:43] offset:9216
    ds_write_b128 v6, v[44:47] offset:13824
    ds_write_b128 v8, v[48:51] offset:0
    ds_write_b128 v8, v[52:55] offset:5120
    ds_write_b128 v8, v[56:59] offset:10240
    ds_write_b128 v8, v[60:63] offset:15360
    buffer_load_dwordx4 v[32:35], v5, s[12:15], s40 offen offset:640
    buffer_load_dwordx4 v[36:39], v5, s[12:15], s41 offen offset:640
    buffer_load_dwordx4 v[40:43], v5, s[12:15], s42 offen offset:640
    buffer_load_dwordx4 v[44:47], v5, s[12:15], s43 offen offset:640
    s_mov_b32 s44, 983040
    buffer_load_dwordx4 v[48:51], v7, s[16:19], s44 offen
    s_mov_b32 s44, 1032192
    buffer_load_dwordx4 v[52:55], v7, s[16:19], s44 offen
    s_mov_b32 s44, 1081344
    buffer_load_dwordx4 v[56:59], v7, s[16:19], s44 offen
    s_mov_b32 s44, 1130496
    buffer_load_dwordx4 v[60:63], v7, s[16:19], s44 offen
    s_waitcnt lgkmcnt(0)
    s_barrier
    ds_read_b128 v[16:19], v9 offset:0
    ds_read_b128 v[20:23], v9 offset:4608
    ds_read_b64_tr_b16 v[24:25], v10 offset:0
    ds_read_b64_tr_b16 v[26:27], v10 offset:1280
    ds_read_b64_tr_b16 v[28:29], v10 offset:64
    ds_read_b64_tr_b16 v[30:31], v10 offset:1344
    ds_read_b128 v[128:131], v9 offset:32
    ds_read_b128 v[132:135], v9 offset:4640
    ds_read_b64_tr_b16 v[136:137], v10 offset:5120
    ds_read_b64_tr_b16 v[138:139], v10 offset:6400
    ds_read_b64_tr_b16 v[140:141], v10 offset:5184
    ds_read_b64_tr_b16 v[142:143], v10 offset:6464
    s_waitcnt lgkmcnt(6)
    v_mfma_f32_32x32x16_bf16 v[64:79], v[16:19], v[24:27], v[64:79]
    v_mfma_f32_32x32x16_bf16 v[80:95], v[16:19], v[28:31], v[80:95]
    v_mfma_f32_32x32x16_bf16 v[96:111], v[20:23], v[24:27], v[96:111]
    v_mfma_f32_32x32x16_bf16 v[112:127], v[20:23], v[28:31], v[112:127]
    ds_read_b128 v[16:19], v9 offset:64
    ds_read_b128 v[20:23], v9 offset:4672
    ds_read_b64_tr_b16 v[24:25], v10 offset:10240
    ds_read_b64_tr_b16 v[26:27], v10 offset:11520
    ds_read_b64_tr_b16 v[28:29], v10 offset:10304
    ds_read_b64_tr_b16 v[30:31], v10 offset:11584
    s_waitcnt lgkmcnt(6)
    v_mfma_f32_32x32x16_bf16 v[64:79], v[128:131], v[136:139], v[64:79]
    v_mfma_f32_32x32x16_bf16 v[80:95], v[128:131], v[140:143], v[80:95]
    v_mfma_f32_32x32x16_bf16 v[96:111], v[132:135], v[136:139], v[96:111]
    v_mfma_f32_32x32x16_bf16 v[112:127], v[132:135], v[140:143], v[112:127]
    ds_read_b128 v[128:131], v9 offset:96
    ds_read_b128 v[132:135], v9 offset:4704
    ds_read_b64_tr_b16 v[136:137], v10 offset:15360
    ds_read_b64_tr_b16 v[138:139], v10 offset:16640
    ds_read_b64_tr_b16 v[140:141], v10 offset:15424
    ds_read_b64_tr_b16 v[142:143], v10 offset:16704
    s_waitcnt lgkmcnt(6)
    v_mfma_f32_32x32x16_bf16 v[64:79], v[16:19], v[24:27], v[64:79]
    v_mfma_f32_32x32x16_bf16 v[80:95], v[16:19], v[28:31], v[80:95]
    v_mfma_f32_32x32x16_bf16 v[96:111], v[20:23], v[24:27], v[96:111]
    v_mfma_f32_32x32x16_bf16 v[112:127], v[20:23], v[28:31], v[112:127]
    s_waitcnt lgkmcnt(0)
    v_mfma_f32_32x32x16_bf16 v[64:79], v[128:131], v[136:139], v[64:79]
    v_mfma_f32_32x32x16_bf16 v[80:95], v[128:131], v[140:143], v[80:95]
    v_mfma_f32_32x32x16_bf16 v[96:111], v[132:135], v[136:139], v[96:111]
    v_mfma_f32_32x32x16_bf16 v[112:127], v[132:135], v[140:143], v[112:127]
    s_waitcnt vmcnt(0)
    ds_write_b128 v6, v[32:35] offset:38912
    ds_write_b128 v6, v[36:39] offset:43520
    ds_write_b128 v6, v[40:43] offset:48128
    ds_write_b128 v6, v[44:47] offset:52736
    ds_write_b128 v8, v[48:51] offset:38912
    ds_write_b128 v8, v[52:55] offset:44032
    ds_write_b128 v8, v[56:59] offset:49152
    ds_write_b128 v8, v[60:63] offset:54272
    buffer_load_dwordx4 v[32:35], v5, s[12:15], s40 offen offset:768
    buffer_load_dwordx4 v[36:39], v5, s[12:15], s41 offen offset:768
    buffer_load_dwordx4 v[40:43], v5, s[12:15], s42 offen offset:768
    buffer_load_dwordx4 v[44:47], v5, s[12:15], s43 offen offset:768
    s_mov_b32 s44, 1179648
    buffer_load_dwordx4 v[48:51], v7, s[16:19], s44 offen
    s_mov_b32 s44, 1228800
    buffer_load_dwordx4 v[52:55], v7, s[16:19], s44 offen
    s_mov_b32 s44, 1277952
    buffer_load_dwordx4 v[56:59], v7, s[16:19], s44 offen
    s_mov_b32 s44, 1327104
    buffer_load_dwordx4 v[60:63], v7, s[16:19], s44 offen
    s_waitcnt lgkmcnt(0)
    s_barrier
    ds_read_b128 v[16:19], v9 offset:38912
    ds_read_b128 v[20:23], v9 offset:43520
    ds_read_b64_tr_b16 v[24:25], v11 offset:0
    ds_read_b64_tr_b16 v[26:27], v11 offset:1280
    ds_read_b64_tr_b16 v[28:29], v11 offset:64
    ds_read_b64_tr_b16 v[30:31], v11 offset:1344
    ds_read_b128 v[128:131], v9 offset:38944
    ds_read_b128 v[132:135], v9 offset:43552
    ds_read_b64_tr_b16 v[136:137], v11 offset:5120
    ds_read_b64_tr_b16 v[138:139], v11 offset:6400
    ds_read_b64_tr_b16 v[140:141], v11 offset:5184
    ds_read_b64_tr_b16 v[142:143], v11 offset:6464
    s_waitcnt lgkmcnt(6)
    v_mfma_f32_32x32x16_bf16 v[64:79], v[16:19], v[24:27], v[64:79]
    v_mfma_f32_32x32x16_bf16 v[80:95], v[16:19], v[28:31], v[80:95]
    v_mfma_f32_32x32x16_bf16 v[96:111], v[20:23], v[24:27], v[96:111]
    v_mfma_f32_32x32x16_bf16 v[112:127], v[20:23], v[28:31], v[112:127]
    ds_read_b128 v[16:19], v9 offset:38976
    ds_read_b128 v[20:23], v9 offset:43584
    ds_read_b64_tr_b16 v[24:25], v11 offset:10240
    ds_read_b64_tr_b16 v[26:27], v11 offset:11520
    ds_read_b64_tr_b16 v[28:29], v11 offset:10304
    ds_read_b64_tr_b16 v[30:31], v11 offset:11584
    s_waitcnt lgkmcnt(6)
    v_mfma_f32_32x32x16_bf16 v[64:79], v[128:131], v[136:139], v[64:79]
    v_mfma_f32_32x32x16_bf16 v[80:95], v[128:131], v[140:143], v[80:95]
    v_mfma_f32_32x32x16_bf16 v[96:111], v[132:135], v[136:139], v[96:111]
    v_mfma_f32_32x32x16_bf16 v[112:127], v[132:135], v[140:143], v[112:127]
    ds_read_b128 v[128:131], v9 offset:39008
    ds_read_b128 v[132:135], v9 offset:43616
    ds_read_b64_tr_b16 v[136:137], v11 offset:15360
    ds_read_b64_tr_b16 v[138:139], v11 offset:16640
    ds_read_b64_tr_b16 v[140:141], v11 offset:15424
    ds_read_b64_tr_b16 v[142:143], v11 offset:16704
    s_waitcnt lgkmcnt(6)
    v_mfma_f32_32x32x16_bf16 v[64:79], v[16:19], v[24:27], v[64:79]
    v_mfma_f32_32x32x16_bf16 v[80:95], v[16:19], v[28:31], v[80:95]
    v_mfma_f32_32x32x16_bf16 v[96:111], v[20:23], v[24:27], v[96:111]
    v_mfma_f32_32x32x16_bf16 v[112:127], v[20:23], v[28:31], v[112:127]
    s_waitcnt lgkmcnt(0)
    v_mfma_f32_32x32x16_bf16 v[64:79], v[128:131], v[136:139], v[64:79]
    v_mfma_f32_32x32x16_bf16 v[80:95], v[128:131], v[140:143], v[80:95]
    v_mfma_f32_32x32x16_bf16 v[96:111], v[132:135], v[136:139], v[96:111]
    v_mfma_f32_32x32x16_bf16 v[112:127], v[132:135], v[140:143], v[112:127]
    s_waitcnt vmcnt(0)
    ds_write_b128 v6, v[32:35] offset:0
    ds_write_b128 v6, v[36:39] offset:4608
    ds_write_b128 v6, v[40:43] offset:9216
    ds_write_b128 v6, v[44:47] offset:13824
    ds_write_b128 v8, v[48:51] offset:0
    ds_write_b128 v8, v[52:55] offset:5120
    ds_write_b128 v8, v[56:59] offset:10240
    ds_write_b128 v8, v[60:63] offset:15360
    buffer_load_dwordx4 v[32:35], v5, s[12:15], s40 offen offset:896
    buffer_load_dwordx4 v[36:39], v5, s[12:15], s41 offen offset:896
    buffer_load_dwordx4 v[40:43], v5, s[12:15], s42 offen offset:896
    buffer_load_dwordx4 v[44:47], v5, s[12:15], s43 offen offset:896
    s_mov_b32 s44, 1376256
    buffer_load_dwordx4 v[48:51], v7, s[16:19], s44 offen
    s_mov_b32 s44, 1425408
    buffer_load_dwordx4 v[52:55], v7, s[16:19], s44 offen
    s_mov_b32 s44, 1474560
    buffer_load_dwordx4 v[56:59], v7, s[16:19], s44 offen
    s_mov_b32 s44, 1523712
    buffer_load_dwordx4 v[60:63], v7, s[16:19], s44 offen
    s_waitcnt lgkmcnt(0)
    s_barrier
    ds_read_b128 v[16:19], v9 offset:0
    ds_read_b128 v[20:23], v9 offset:4608
    ds_read_b64_tr_b16 v[24:25], v10 offset:0
    ds_read_b64_tr_b16 v[26:27], v10 offset:1280
    ds_read_b64_tr_b16 v[28:29], v10 offset:64
    ds_read_b64_tr_b16 v[30:31], v10 offset:1344
    ds_read_b128 v[128:131], v9 offset:32
    ds_read_b128 v[132:135], v9 offset:4640
    ds_read_b64_tr_b16 v[136:137], v10 offset:5120
    ds_read_b64_tr_b16 v[138:139], v10 offset:6400
    ds_read_b64_tr_b16 v[140:141], v10 offset:5184
    ds_read_b64_tr_b16 v[142:143], v10 offset:6464
    s_waitcnt lgkmcnt(6)
    v_mfma_f32_32x32x16_bf16 v[64:79], v[16:19], v[24:27], v[64:79]
    v_mfma_f32_32x32x16_bf16 v[80:95], v[16:19], v[28:31], v[80:95]
    v_mfma_f32_32x32x16_bf16 v[96:111], v[20:23], v[24:27], v[96:111]
    v_mfma_f32_32x32x16_bf16 v[112:127], v[20:23], v[28:31], v[112:127]
    ds_read_b128 v[16:19], v9 offset:64
    ds_read_b128 v[20:23], v9 offset:4672
    ds_read_b64_tr_b16 v[24:25], v10 offset:10240
    ds_read_b64_tr_b16 v[26:27], v10 offset:11520
    ds_read_b64_tr_b16 v[28:29], v10 offset:10304
    ds_read_b64_tr_b16 v[30:31], v10 offset:11584
    s_waitcnt lgkmcnt(6)
    v_mfma_f32_32x32x16_bf16 v[64:79], v[128:131], v[136:139], v[64:79]
    v_mfma_f32_32x32x16_bf16 v[80:95], v[128:131], v[140:143], v[80:95]
    v_mfma_f32_32x32x16_bf16 v[96:111], v[132:135], v[136:139], v[96:111]
    v_mfma_f32_32x32x16_bf16 v[112:127], v[132:135], v[140:143], v[112:127]
    ds_read_b128 v[128:131], v9 offset:96
    ds_read_b128 v[132:135], v9 offset:4704
    ds_read_b64_tr_b16 v[136:137], v10 offset:15360
    ds_read_b64_tr_b16 v[138:139], v10 offset:16640
    ds_read_b64_tr_b16 v[140:141], v10 offset:15424
    ds_read_b64_tr_b16 v[142:143], v10 offset:16704
    s_waitcnt lgkmcnt(6)
    v_mfma_f32_32x32x16_bf16 v[64:79], v[16:19], v[24:27], v[64:79]
    v_mfma_f32_32x32x16_bf16 v[80:95], v[16:19], v[28:31], v[80:95]
    v_mfma_f32_32x32x16_bf16 v[96:111], v[20:23], v[24:27], v[96:111]
    v_mfma_f32_32x32x16_bf16 v[112:127], v[20:23], v[28:31], v[112:127]
    s_waitcnt lgkmcnt(0)
    v_mfma_f32_32x32x16_bf16 v[64:79], v[128:131], v[136:139], v[64:79]
    v_mfma_f32_32x32x16_bf16 v[80:95], v[128:131], v[140:143], v[80:95]
    v_mfma_f32_32x32x16_bf16 v[96:111], v[132:135], v[136:139], v[96:111]
    v_mfma_f32_32x32x16_bf16 v[112:127], v[132:135], v[140:143], v[112:127]
    s_waitcnt vmcnt(0)
    ds_write_b128 v6, v[32:35] offset:38912
    ds_write_b128 v6, v[36:39] offset:43520
    ds_write_b128 v6, v[40:43] offset:48128
    ds_write_b128 v6, v[44:47] offset:52736
    ds_write_b128 v8, v[48:51] offset:38912
    ds_write_b128 v8, v[52:55] offset:44032
    ds_write_b128 v8, v[56:59] offset:49152
    ds_write_b128 v8, v[60:63] offset:54272
    s_waitcnt lgkmcnt(0)
    s_barrier
    ds_read_b128 v[16:19], v9 offset:38912
    ds_read_b128 v[20:23], v9 offset:43520
    ds_read_b64_tr_b16 v[24:25], v11 offset:0
    ds_read_b64_tr_b16 v[26:27], v11 offset:1280
    ds_read_b64_tr_b16 v[28:29], v11 offset:64
    ds_read_b64_tr_b16 v[30:31], v11 offset:1344
    ds_read_b128 v[128:131], v9 offset:38944
    ds_read_b128 v[132:135], v9 offset:43552
    ds_read_b64_tr_b16 v[136:137], v11 offset:5120
    ds_read_b64_tr_b16 v[138:139], v11 offset:6400
    ds_read_b64_tr_b16 v[140:141], v11 offset:5184
    ds_read_b64_tr_b16 v[142:143], v11 offset:6464
    s_waitcnt lgkmcnt(6)
    v_mfma_f32_32x32x16_bf16 v[64:79], v[16:19], v[24:27], v[64:79]
    v_mfma_f32_32x32x16_bf16 v[80:95], v[16:19], v[28:31], v[80:95]
    v_mfma_f32_32x32x16_bf16 v[96:111], v[20:23], v[24:27], v[96:111]
    v_mfma_f32_32x32x16_bf16 v[112:127], v[20:23], v[28:31], v[112:127]
    ds_read_b128 v[16:19], v9 offset:38976
    ds_read_b128 v[20:23], v9 offset:43584
    ds_read_b64_tr_b16 v[24:25], v11 offset:10240
    ds_read_b64_tr_b16 v[26:27], v11 offset:11520
    ds_read_b64_tr_b16 v[28:29], v11 offset:10304
    ds_read_b64_tr_b16 v[30:31], v11 offset:11584
    s_waitcnt lgkmcnt(6)
    v_mfma_f32_32x32x16_bf16 v[64:79], v[128:131], v[136:139], v[64:79]
    v_mfma_f32_32x32x16_bf16 v[80:95], v[128:131], v[140:143], v[80:95]
    v_mfma_f32_32x32x16_bf16 v[96:111], v[132:135], v[136:139], v[96:111]
    v_mfma_f32_32x32x16_bf16 v[112:127], v[132:135], v[140:143], v[112:127]
    ds_read_b128 v[128:131], v9 offset:39008
    ds_read_b128 v[132:135], v9 offset:43616
    ds_read_b64_tr_b16 v[136:137], v11 offset:15360
    ds_read_b64_tr_b16 v[138:139], v11 offset:16640
    ds_read_b64_tr_b16 v[140:141], v11 offset:15424
    ds_read_b64_tr_b16 v[142:143], v11 offset:16704
    s_waitcnt lgkmcnt(6)
    v_mfma_f32_32x32x16_bf16 v[64:79], v[16:19], v[24:27], v[64:79]
    v_mfma_f32_32x32x16_bf16 v[80:95], v[16:19], v[28:31], v[80:95]
    v_mfma_f32_32x32x16_bf16 v[96:111], v[20:23], v[24:27], v[96:111]
    v_mfma_f32_32x32x16_bf16 v[112:127], v[20:23], v[28:31], v[112:127]
    s_waitcnt lgkmcnt(0)
    v_mfma_f32_32x32x16_bf16 v[64:79], v[128:131], v[136:139], v[64:79]
    v_mfma_f32_32x32x16_bf16 v[80:95], v[128:131], v[140:143], v[80:95]
    v_mfma_f32_32x32x16_bf16 v[96:111], v[132:135], v[136:139], v[96:111]
    v_mfma_f32_32x32x16_bf16 v[112:127], v[132:135], v[140:143], v[112:127]
    s_nop 7
    s_nop 7
    s_lshl_b32 s38, s26, 21
    s_add_u32 s37, s38, 8388608
    v_bfe_u32 v3, v1, 4, 1
    v_lshlrev_b32 v3, 16, v3
    v_lshrrev_b32 v4, 5, v1
    v_lshl_add_u32 v3, v4, 8, v3
    v_and_b32 v4, 15, v1
    v_lshl_add_u32 v3, v4, 4, v3
    v_cvt_pk_bf16_f32 v32, v64, v65
    v_cvt_pk_bf16_f32 v33, v66, v67
    v_cvt_pk_bf16_f32 v34, v68, v69
    v_cvt_pk_bf16_f32 v35, v70, v71
    s_lshl_b32 s38, s31, 3
    s_lshl_b32 s39, s34, 2
    s_add_u32 s38, s38, s39
    s_add_u32 s38, s38, 0
    s_lshl_b32 s38, s38, 7
    s_lshl_b32 s39, s29, 3
    s_add_u32 s38, s38, s39
    s_lshl_b32 s39, s33, 2
    s_add_u32 s38, s38, s39
    s_add_u32 s38, s38, 0
    s_lshl_b32 s38, s38, 9
    s_add_u32 s38, s38, s37
    buffer_store_dwordx4 v[32:35], v3, s[20:23], s38 offen
    v_cvt_pk_bf16_f32 v36, v72, v73
    v_cvt_pk_bf16_f32 v37, v74, v75
    v_cvt_pk_bf16_f32 v38, v76, v77
    v_cvt_pk_bf16_f32 v39, v78, v79
    s_lshl_b32 s38, s31, 3
    s_lshl_b32 s39, s34, 2
    s_add_u32 s38, s38, s39
    s_add_u32 s38, s38, 0
    s_lshl_b32 s38, s38, 7
    s_lshl_b32 s39, s29, 3
    s_add_u32 s38, s38, s39
    s_lshl_b32 s39, s33, 2
    s_add_u32 s38, s38, s39
    s_add_u32 s38, s38, 1
    s_lshl_b32 s38, s38, 9
    s_add_u32 s38, s38, s37
    buffer_store_dwordx4 v[36:39], v3, s[20:23], s38 offen
    v_cvt_pk_bf16_f32 v40, v80, v81
    v_cvt_pk_bf16_f32 v41, v82, v83
    v_cvt_pk_bf16_f32 v42, v84, v85
    v_cvt_pk_bf16_f32 v43, v86, v87
    s_lshl_b32 s38, s31, 3
    s_lshl_b32 s39, s34, 2
    s_add_u32 s38, s38, s39
    s_add_u32 s38, s38, 2
    s_lshl_b32 s38, s38, 7
    s_lshl_b32 s39, s29, 3
    s_add_u32 s38, s38, s39
    s_lshl_b32 s39, s33, 2
    s_add_u32 s38, s38, s39
    s_add_u32 s38, s38, 0
    s_lshl_b32 s38, s38, 9
    s_add_u32 s38, s38, s37
    buffer_store_dwordx4 v[40:43], v3, s[20:23], s38 offen
    v_cvt_pk_bf16_f32 v44, v88, v89
    v_cvt_pk_bf16_f32 v45, v90, v91
    v_cvt_pk_bf16_f32 v46, v92, v93
    v_cvt_pk_bf16_f32 v47, v94, v95
    s_lshl_b32 s38, s31, 3
    s_lshl_b32 s39, s34, 2
    s_add_u32 s38, s38, s39
    s_add_u32 s38, s38, 2
    s_lshl_b32 s38, s38, 7
    s_lshl_b32 s39, s29, 3
    s_add_u32 s38, s38, s39
    s_lshl_b32 s39, s33, 2
    s_add_u32 s38, s38, s39
    s_add_u32 s38, s38, 1
    s_lshl_b32 s38, s38, 9
    s_add_u32 s38, s38, s37
    buffer_store_dwordx4 v[44:47], v3, s[20:23], s38 offen
    v_cvt_pk_bf16_f32 v48, v96, v97
    v_cvt_pk_bf16_f32 v49, v98, v99
    v_cvt_pk_bf16_f32 v50, v100, v101
    v_cvt_pk_bf16_f32 v51, v102, v103
    s_lshl_b32 s38, s31, 3
    s_lshl_b32 s39, s34, 2
    s_add_u32 s38, s38, s39
    s_add_u32 s38, s38, 0
    s_lshl_b32 s38, s38, 7
    s_lshl_b32 s39, s29, 3
    s_add_u32 s38, s38, s39
    s_lshl_b32 s39, s33, 2
    s_add_u32 s38, s38, s39
    s_add_u32 s38, s38, 2
    s_lshl_b32 s38, s38, 9
    s_add_u32 s38, s38, s37
    buffer_store_dwordx4 v[48:51], v3, s[20:23], s38 offen
    v_cvt_pk_bf16_f32 v52, v104, v105
    v_cvt_pk_bf16_f32 v53, v106, v107
    v_cvt_pk_bf16_f32 v54, v108, v109
    v_cvt_pk_bf16_f32 v55, v110, v111
    s_lshl_b32 s38, s31, 3
    s_lshl_b32 s39, s34, 2
    s_add_u32 s38, s38, s39
    s_add_u32 s38, s38, 0
    s_lshl_b32 s38, s38, 7
    s_lshl_b32 s39, s29, 3
    s_add_u32 s38, s38, s39
    s_lshl_b32 s39, s33, 2
    s_add_u32 s38, s38, s39
    s_add_u32 s38, s38, 3
    s_lshl_b32 s38, s38, 9
    s_add_u32 s38, s38, s37
    buffer_store_dwordx4 v[52:55], v3, s[20:23], s38 offen
    v_cvt_pk_bf16_f32 v56, v112, v113
    v_cvt_pk_bf16_f32 v57, v114, v115
    v_cvt_pk_bf16_f32 v58, v116, v117
    v_cvt_pk_bf16_f32 v59, v118, v119
    s_lshl_b32 s38, s31, 3
    s_lshl_b32 s39, s34, 2
    s_add_u32 s38, s38, s39
    s_add_u32 s38, s38, 2
    s_lshl_b32 s38, s38, 7
    s_lshl_b32 s39, s29, 3
    s_add_u32 s38, s38, s39
    s_lshl_b32 s39, s33, 2
    s_add_u32 s38, s38, s39
    s_add_u32 s38, s38, 2
    s_lshl_b32 s38, s38, 9
    s_add_u32 s38, s38, s37
    buffer_store_dwordx4 v[56:59], v3, s[20:23], s38 offen
    v_cvt_pk_bf16_f32 v60, v120, v121
    v_cvt_pk_bf16_f32 v61, v122, v123
    v_cvt_pk_bf16_f32 v62, v124, v125
    v_cvt_pk_bf16_f32 v63, v126, v127
    s_lshl_b32 s38, s31, 3
    s_lshl_b32 s39, s34, 2
    s_add_u32 s38, s38, s39
    s_add_u32 s38, s38, 2
    s_lshl_b32 s38, s38, 7
    s_lshl_b32 s39, s29, 3
    s_add_u32 s38, s38, s39
    s_lshl_b32 s39, s33, 2
    s_add_u32 s38, s38, s39
    s_add_u32 s38, s38, 3
    s_lshl_b32 s38, s38, 9
    s_add_u32 s38, s38, s37
    buffer_store_dwordx4 v[60:63], v3, s[20:23], s38 offen
L_qkv_done:
    s_endpgm
.section .rodata,"a"
.p2align 6
.amdhsa_kernel qkv_kernel
  .amdhsa_next_free_vgpr 144
  .amdhsa_next_free_sgpr 102
  .amdhsa_accum_offset 144
  .amdhsa_group_segment_fixed_size 0
  .amdhsa_kernarg_size 72
  .amdhsa_user_sgpr_count 2
  .amdhsa_user_sgpr_kernarg_segment_ptr 1
  .amdhsa_system_sgpr_workgroup_id_x 1
.end_amdhsa_kernel
.text

.text
.globl attn_kernel
.p2align 8
.type attn_kernel,@function
attn_kernel:

    s_cmp_ge_u32 s2, 512
    s_cbranch_scc1 L_attn_done
    s_load_dwordx2 s[4:5], s[0:1], 64
    s_lshr_b32 s12, s2, 8
    s_xor_b32 s12, s12, 1
    s_and_b32 s13, s2, 31
    s_bfe_u32 s14, s2, 0x30005
    v_and_b32 v1, 63, v0
    v_lshrrev_b32 v2, 6, v0
    s_nop 0
    v_readfirstlane_b32 s15, v2
    s_waitcnt lgkmcnt(0)
    s_mov_b32 s8, s4
    s_mov_b32 s9, s5
    s_mov_b32 s10, 16777216
    s_mov_b32 s11, 0x00020000
    s_lshl_b32 s16, s12, 21
    s_lshl_b32 s17, s13, 16
    s_add_u32 s16, s16, s17
    s_add_u32 s17, s16, 8388608
    s_add_u32 s16, s16, 4194304
    v_and_b32 v3, 31, v0
    v_cmp_eq_u32 vcc, 0, v3
    v_mov_b32 v110, 0
    v_mov_b32 v111, 0x3f803f80
    v_cndmask_b32 v110, v110, v111, vcc
    v_mov_b32 v111, v110
    v_mov_b32 v112, v110
    v_mov_b32 v113, v110
    v_lshlrev_b32 v3, 4, v0
    ds_write_b128 v3, v[110:113] offset:49152
    v_and_b32 v3, 31, v1
    v_lshrrev_b32 v2, 5, v1
    v_lshlrev_b32 v104, 4, v3
    v_lshl_add_u32 v104, v2, 9, v104
    v_lshlrev_b32 v109, 2, v2
    v_sub_u32 v109, v3, v109
    v_and_b32 v110, 15, v1
    v_lshlrev_b32 v110, 4, v110
    v_lshl_add_u32 v110, v2, 8, v110
    v_add_u32 v110, 8192, v110
    v_mov_b32 v111, 49168
    v_mov_b32 v112, 49152
    v_cmp_eq_u32 vcc, 16, v3
    s_nop 1
    v_cndmask_b32 v111, v111, v112, vcc
    v_cmp_gt_u32 vcc, 16, v3
    s_nop 1
    v_cndmask_b32 v106, v111, v110, vcc
    v_cndmask_b32 v107, 0, 1, vcc
    s_lshl_b32 s18, s12, 21
    s_lshl_b32 s19, s13, 6
    s_lshl_b32 s20, s14, 3
    s_add_u32 s19, s19, s20
    s_add_u32 s19, s19, s15
    s_lshl_b32 s19, s19, 10
    s_add_u32 s18, s18, s19
    buffer_load_dwordx4 v[4:7], v104, s[8:11], s18 offen
    v_lshlrev_b32 v114, 4, v1
    v_mov_b32 v8, 0
    v_mov_b32 v9, 0
    v_mov_b32 v10, 0
    v_mov_b32 v11, 0
    v_mov_b32 v12, 0
    v_mov_b32 v13, 0
    v_mov_b32 v14, 0
    v_mov_b32 v15, 0
    v_mov_b32 v16, 0
    v_mov_b32 v17, 0
    v_mov_b32 v18, 0
    v_mov_b32 v19, 0
    v_mov_b32 v20, 0
    v_mov_b32 v21, 0
    v_mov_b32 v22, 0
    v_mov_b32 v23, 0
    v_mov_b32 v24, 0
    v_mov_b32 v25, 0
    v_mov_b32 v26, 0
    v_mov_b32 v27, 0
    v_mov_b32 v28, 0
    v_mov_b32 v29, 0
    v_mov_b32 v30, 0
    v_mov_b32 v31, 0
    v_mov_b32 v32, 0
    v_mov_b32 v33, 0
    v_mov_b32 v34, 0
    v_mov_b32 v35, 0
    v_mov_b32 v36, 0
    v_mov_b32 v37, 0
    v_mov_b32 v38, 0
    v_mov_b32 v39, 0
    v_mov_b32 v117, 0xf149f2ca
    v_mov_b32 v108, 0xff7fffff
    s_lshl_b32 s21, s15, 10
    s_cmp_eq_u32 s12, 0
    s_cbranch_scc1 L_attn_A
    s_mov_b32 s28, 0
    s_mov_b32 s29, 0
    s_add_u32 s22, s21, s28
    s_add_u32 s23, s22, s16
    s_add_u32 m0, s29, s21
    s_nop 0
    buffer_load_dwordx4 v114, s[8:11], s23 offen lds
    s_add_u32 s23, s22, s17
    s_add_u32 m0, m0, 8192
    s_nop 0
    buffer_load_dwordx4 v114, s[8:11], s23 offen lds
    s_mov_b32 s28, 8192
    s_mov_b32 s29, 16384
    s_add_u32 s22, s21, s28
    s_add_u32 s23, s22, s16
    s_add_u32 m0, s29, s21
    s_nop 0
    buffer_load_dwordx4 v114, s[8:11], s23 offen lds
    s_add_u32 s23, s22, s17
    s_add_u32 m0, m0, 8192
    s_nop 0
    buffer_load_dwordx4 v114, s[8:11], s23 offen lds
    s_mov_b32 s24, 0
    s_mov_b32 s25, 0
    s_mov_b32 s26, 32768
    s_mov_b32 s27, 16384
L_B_stage:
    s_cmp_eq_u32 s24, 7
    s_cbranch_scc1 L_B_w0
    s_waitcnt vmcnt(2)
    s_branch L_B_w1
L_B_w0:
    s_waitcnt vmcnt(0)
L_B_w1:
    s_waitcnt lgkmcnt(0)
    s_barrier
    s_cmp_ge_u32 s24, 6
    s_cbranch_scc1 L_B_nodma
    s_add_u32 s22, s21, s27
    s_add_u32 s23, s22, s16
    s_add_u32 m0, s26, s21
    s_nop 0
    buffer_load_dwordx4 v114, s[8:11], s23 offen lds
    s_add_u32 s23, s22, s17
    s_add_u32 m0, m0, 8192
    s_nop 0
    buffer_load_dwordx4 v114, s[8:11], s23 offen lds
L_B_nodma:
    v_add_u32 v115, s25, v104
    v_mad_u32_u24 v116, s25, v107, v106
    ds_read_b128 v[80:83], v115 offset:0
    ds_read_b128 v[84:87], v115 offset:1024
    ds_read_b128 v[88:91], v116 offset:0
    ds_read_b128 v[92:95], v116 offset:512
    s_waitcnt lgkmcnt(0)
    v_mfma_f32_32x32x16_bf16 v[40:55], v[80:83], v[4:7], v[8:23]
    s_nop 7
    s_nop 6
    v_mfma_f32_32x32x16_bf16 v[56:71], v[84:87], v[4:7], v[8:23]
    s_cmp_eq_u32 s24, 0
    s_cbranch_scc1 rare_B0
retry_B0:
    v_exp_f32 v40, v40
    v_exp_f32 v41, v41
    v_exp_f32 v42, v42
    v_exp_f32 v43, v43
    v_exp_f32 v44, v44
    v_exp_f32 v45, v45
    v_exp_f32 v46, v46
    v_exp_f32 v47, v47
    v_exp_f32 v48, v48
    v_exp_f32 v49, v49
    v_exp_f32 v50, v50
    v_exp_f32 v51, v51
    v_exp_f32 v52, v52
    v_exp_f32 v53, v53
    v_exp_f32 v54, v54
    v_exp_f32 v55, v55
    v_cvt_pk_bf16_f32 v72, v40, v41
    v_cvt_pk_bf16_f32 v73, v42, v43
    v_cvt_pk_bf16_f32 v74, v44, v45
    v_cvt_pk_bf16_f32 v75, v46, v47
    v_cvt_pk_bf16_f32 v76, v48, v49
    v_cvt_pk_bf16_f32 v77, v50, v51
    v_cvt_pk_bf16_f32 v78, v52, v53
    v_cvt_pk_bf16_f32 v79, v54, v55
    v_or_b32 v110, v72, v73
    v_or_b32 v111, v74, v75
    v_or_b32 v112, v76, v77
    v_or_b32 v113, v78, v79
    v_or_b32 v110, v110, v111
    v_or_b32 v112, v112, v113
    v_or_b32 v110, v110, v112
    v_and_b32 v110, 0x40004000, v110
    v_cmp_ne_u32 vcc, 0, v110
    s_cbranch_vccnz rare_B0
    ds_read_b128 v[80:83], v115 offset:2048
    ds_read_b128 v[96:99], v116 offset:1024
    ds_read_b128 v[100:103], v116 offset:1536
    v_mfma_f32_32x32x16_bf16 v[24:39], v[88:91], v[72:75], v[24:39]
    v_mfma_f32_32x32x16_bf16 v[24:39], v[92:95], v[76:79], v[24:39]
    s_waitcnt lgkmcnt(0)
    v_mfma_f32_32x32x16_bf16 v[40:55], v[80:83], v[4:7], v[8:23]
retry_B1:
    v_exp_f32 v56, v56
    v_exp_f32 v57, v57
    v_exp_f32 v58, v58
    v_exp_f32 v59, v59
    v_exp_f32 v60, v60
    v_exp_f32 v61, v61
    v_exp_f32 v62, v62
    v_exp_f32 v63, v63
    v_exp_f32 v64, v64
    v_exp_f32 v65, v65
    v_exp_f32 v66, v66
    v_exp_f32 v67, v67
    v_exp_f32 v68, v68
    v_exp_f32 v69, v69
    v_exp_f32 v70, v70
    v_exp_f32 v71, v71
    v_cvt_pk_bf16_f32 v72, v56, v57
    v_cvt_pk_bf16_f32 v73, v58, v59
    v_cvt_pk_bf16_f32 v74, v60, v61
    v_cvt_pk_bf16_f32 v75, v62, v63
    v_cvt_pk_bf16_f32 v76, v64, v65
    v_cvt_pk_bf16_f32 v77, v66, v67
    v_cvt_pk_bf16_f32 v78, v68, v69
    v_cvt_pk_bf16_f32 v79, v70, v71
    v_or_b32 v110, v72, v73
    v_or_b32 v111, v74, v75
    v_or_b32 v112, v76, v77
    v_or_b32 v113, v78, v79
    v_or_b32 v110, v110, v111
    v_or_b32 v112, v112, v113
    v_or_b32 v110, v110, v112
    v_and_b32 v110, 0x40004000, v110
    v_cmp_ne_u32 vcc, 0, v110
    s_cbranch_vccnz rare_B1
    ds_read_b128 v[84:87], v115 offset:3072
    ds_read_b128 v[88:91], v116 offset:2048
    ds_read_b128 v[92:95], v116 offset:2560
    v_mfma_f32_32x32x16_bf16 v[24:39], v[96:99], v[72:75], v[24:39]
    v_mfma_f32_32x32x16_bf16 v[24:39], v[100:103], v[76:79], v[24:39]
    s_waitcnt lgkmcnt(0)
    v_mfma_f32_32x32x16_bf16 v[56:71], v[84:87], v[4:7], v[8:23]
retry_B2:
    v_exp_f32 v40, v40
    v_exp_f32 v41, v41
    v_exp_f32 v42, v42
    v_exp_f32 v43, v43
    v_exp_f32 v44, v44
    v_exp_f32 v45, v45
    v_exp_f32 v46, v46
    v_exp_f32 v47, v47
    v_exp_f32 v48, v48
    v_exp_f32 v49, v49
    v_exp_f32 v50, v50
    v_exp_f32 v51, v51
    v_exp_f32 v52, v52
    v_exp_f32 v53, v53
    v_exp_f32 v54, v54
    v_exp_f32 v55, v55
    v_cvt_pk_bf16_f32 v72, v40, v41
    v_cvt_pk_bf16_f32 v73, v42, v43
    v_cvt_pk_bf16_f32 v74, v44, v45
    v_cvt_pk_bf16_f32 v75, v46, v47
    v_cvt_pk_bf16_f32 v76, v48, v49
    v_cvt_pk_bf16_f32 v77, v50, v51
    v_cvt_pk_bf16_f32 v78, v52, v53
    v_cvt_pk_bf16_f32 v79, v54, v55
    v_or_b32 v110, v72, v73
    v_or_b32 v111, v74, v75
    v_or_b32 v112, v76, v77
    v_or_b32 v113, v78, v79
    v_or_b32 v110, v110, v111
    v_or_b32 v112, v112, v113
    v_or_b32 v110, v110, v112
    v_and_b32 v110, 0x40004000, v110
    v_cmp_ne_u32 vcc, 0, v110
    s_cbranch_vccnz rare_B2
    ds_read_b128 v[80:83], v115 offset:4096
    ds_read_b128 v[96:99], v116 offset:3072
    ds_read_b128 v[100:103], v116 offset:3584
    v_mfma_f32_32x32x16_bf16 v[24:39], v[88:91], v[72:75], v[24:39]
    v_mfma_f32_32x32x16_bf16 v[24:39], v[92:95], v[76:79], v[24:39]
    s_waitcnt lgkmcnt(0)
    v_mfma_f32_32x32x16_bf16 v[40:55], v[80:83], v[4:7], v[8:23]
retry_B3:
    v_exp_f32 v56, v56
    v_exp_f32 v57, v57
    v_exp_f32 v58, v58
    v_exp_f32 v59, v59
    v_exp_f32 v60, v60
    v_exp_f32 v61, v61
    v_exp_f32 v62, v62
    v_exp_f32 v63, v63
    v_exp_f32 v64, v64
    v_exp_f32 v65, v65
    v_exp_f32 v66, v66
    v_exp_f32 v67, v67
    v_exp_f32 v68, v68
    v_exp_f32 v69, v69
    v_exp_f32 v70, v70
    v_exp_f32 v71, v71
    v_cvt_pk_bf16_f32 v72, v56, v57
    v_cvt_pk_bf16_f32 v73, v58, v59
    v_cvt_pk_bf16_f32 v74, v60, v61
    v_cvt_pk_bf16_f32 v75, v62, v63
    v_cvt_pk_bf16_f32 v76, v64, v65
    v_cvt_pk_bf16_f32 v77, v66, v67
    v_cvt_pk_bf16_f32 v78, v68, v69
    v_cvt_pk_bf16_f32 v79, v70, v71
    v_or_b32 v110, v72, v73
    v_or_b32 v111, v74, v75
    v_or_b32 v112, v76, v77
    v_or_b32 v113, v78, v79
    v_or_b32 v110, v110, v111
    v_or_b32 v112, v112, v113
    v_or_b32 v110, v110, v112
    v_and_b32 v110, 0x40004000, v110
    v_cmp_ne_u32 vcc, 0, v110
    s_cbranch_vccnz rare_B3
    ds_read_b128 v[84:87], v115 offset:5120
    ds_read_b128 v[88:91], v116 offset:4096
    ds_read_b128 v[92:95], v116 offset:4608
    v_mfma_f32_32x32x16_bf16 v[24:39], v[96:99], v[72:75], v[24:39]
    v_mfma_f32_32x32x16_bf16 v[24:39], v[100:103], v[76:79], v[24:39]
    s_waitcnt lgkmcnt(0)
    v_mfma_f32_32x32x16_bf16 v[56:71], v[84:87], v[4:7], v[8:23]
retry_B4:
    v_exp_f32 v40, v40
    v_exp_f32 v41, v41
    v_exp_f32 v42, v42
    v_exp_f32 v43, v43
    v_exp_f32 v44, v44
    v_exp_f32 v45, v45
    v_exp_f32 v46, v46
    v_exp_f32 v47, v47
    v_exp_f32 v48, v48
    v_exp_f32 v49, v49
    v_exp_f32 v50, v50
    v_exp_f32 v51, v51
    v_exp_f32 v52, v52
    v_exp_f32 v53, v53
    v_exp_f32 v54, v54
    v_exp_f32 v55, v55
    v_cvt_pk_bf16_f32 v72, v40, v41
    v_cvt_pk_bf16_f32 v73, v42, v43
    v_cvt_pk_bf16_f32 v74, v44, v45
    v_cvt_pk_bf16_f32 v75, v46, v47
    v_cvt_pk_bf16_f32 v76, v48, v49
    v_cvt_pk_bf16_f32 v77, v50, v51
    v_cvt_pk_bf16_f32 v78, v52, v53
    v_cvt_pk_bf16_f32 v79, v54, v55
    v_or_b32 v110, v72, v73
    v_or_b32 v111, v74, v75
    v_or_b32 v112, v76, v77
    v_or_b32 v113, v78, v79
    v_or_b32 v110, v110, v111
    v_or_b32 v112, v112, v113
    v_or_b32 v110, v110, v112
    v_and_b32 v110, 0x40004000, v110
    v_cmp_ne_u32 vcc, 0, v110
    s_cbranch_vccnz rare_B4
    ds_read_b128 v[80:83], v115 offset:6144
    ds_read_b128 v[96:99], v116 offset:5120
    ds_read_b128 v[100:103], v116 offset:5632
    v_mfma_f32_32x32x16_bf16 v[24:39], v[88:91], v[72:75], v[24:39]
    v_mfma_f32_32x32x16_bf16 v[24:39], v[92:95], v[76:79], v[24:39]
    s_waitcnt lgkmcnt(0)
    v_mfma_f32_32x32x16_bf16 v[40:55], v[80:83], v[4:7], v[8:23]
retry_B5:
    v_exp_f32 v56, v56
    v_exp_f32 v57, v57
    v_exp_f32 v58, v58
    v_exp_f32 v59, v59
    v_exp_f32 v60, v60
    v_exp_f32 v61, v61
    v_exp_f32 v62, v62
    v_exp_f32 v63, v63
    v_exp_f32 v64, v64
    v_exp_f32 v65, v65
    v_exp_f32 v66, v66
    v_exp_f32 v67, v67
    v_exp_f32 v68, v68
    v_exp_f32 v69, v69
    v_exp_f32 v70, v70
    v_exp_f32 v71, v71
    v_cvt_pk_bf16_f32 v72, v56, v57
    v_cvt_pk_bf16_f32 v73, v58, v59
    v_cvt_pk_bf16_f32 v74, v60, v61
    v_cvt_pk_bf16_f32 v75, v62, v63
    v_cvt_pk_bf16_f32 v76, v64, v65
    v_cvt_pk_bf16_f32 v77, v66, v67
    v_cvt_pk_bf16_f32 v78, v68, v69
    v_cvt_pk_bf16_f32 v79, v70, v71
    v_or_b32 v110, v72, v73
    v_or_b32 v111, v74, v75
    v_or_b32 v112, v76, v77
    v_or_b32 v113, v78, v79
    v_or_b32 v110, v110, v111
    v_or_b32 v112, v112, v113
    v_or_b32 v110, v110, v112
    v_and_b32 v110, 0x40004000, v110
    v_cmp_ne_u32 vcc, 0, v110
    s_cbranch_vccnz rare_B5
    ds_read_b128 v[84:87], v115 offset:7168
    ds_read_b128 v[88:91], v116 offset:6144
    ds_read_b128 v[92:95], v116 offset:6656
    v_mfma_f32_32x32x16_bf16 v[24:39], v[96:99], v[72:75], v[24:39]
    v_mfma_f32_32x32x16_bf16 v[24:39], v[100:103], v[76:79], v[24:39]
    s_waitcnt lgkmcnt(0)
    v_mfma_f32_32x32x16_bf16 v[56:71], v[84:87], v[4:7], v[8:23]
retry_B6:
    v_exp_f32 v40, v40
    v_exp_f32 v41, v41
    v_exp_f32 v42, v42
    v_exp_f32 v43, v43
    v_exp_f32 v44, v44
    v_exp_f32 v45, v45
    v_exp_f32 v46, v46
    v_exp_f32 v47, v47
    v_exp_f32 v48, v48
    v_exp_f32 v49, v49
    v_exp_f32 v50, v50
    v_exp_f32 v51, v51
    v_exp_f32 v52, v52
    v_exp_f32 v53, v53
    v_exp_f32 v54, v54
    v_exp_f32 v55, v55
    v_cvt_pk_bf16_f32 v72, v40, v41
    v_cvt_pk_bf16_f32 v73, v42, v43
    v_cvt_pk_bf16_f32 v74, v44, v45
    v_cvt_pk_bf16_f32 v75, v46, v47
    v_cvt_pk_bf16_f32 v76, v48, v49
    v_cvt_pk_bf16_f32 v77, v50, v51
    v_cvt_pk_bf16_f32 v78, v52, v53
    v_cvt_pk_bf16_f32 v79, v54, v55
    v_or_b32 v110, v72, v73
    v_or_b32 v111, v74, v75
    v_or_b32 v112, v76, v77
    v_or_b32 v113, v78, v79
    v_or_b32 v110, v110, v111
    v_or_b32 v112, v112, v113
    v_or_b32 v110, v110, v112
    v_and_b32 v110, 0x40004000, v110
    v_cmp_ne_u32 vcc, 0, v110
    s_cbranch_vccnz rare_B6
    ds_read_b128 v[96:99], v116 offset:7168
    ds_read_b128 v[100:103], v116 offset:7680
    v_mfma_f32_32x32x16_bf16 v[24:39], v[88:91], v[72:75], v[24:39]
    v_mfma_f32_32x32x16_bf16 v[24:39], v[92:95], v[76:79], v[24:39]
    s_waitcnt lgkmcnt(0)
retry_B7:
    v_exp_f32 v56, v56
    v_exp_f32 v57, v57
    v_exp_f32 v58, v58
    v_exp_f32 v59, v59
    v_exp_f32 v60, v60
    v_exp_f32 v61, v61
    v_exp_f32 v62, v62
    v_exp_f32 v63, v63
    v_exp_f32 v64, v64
    v_exp_f32 v65, v65
    v_exp_f32 v66, v66
    v_exp_f32 v67, v67
    v_exp_f32 v68, v68
    v_exp_f32 v69, v69
    v_exp_f32 v70, v70
    v_exp_f32 v71, v71
    v_cvt_pk_bf16_f32 v72, v56, v57
    v_cvt_pk_bf16_f32 v73, v58, v59
    v_cvt_pk_bf16_f32 v74, v60, v61
    v_cvt_pk_bf16_f32 v75, v62, v63
    v_cvt_pk_bf16_f32 v76, v64, v65
    v_cvt_pk_bf16_f32 v77, v66, v67
    v_cvt_pk_bf16_f32 v78, v68, v69
    v_cvt_pk_bf16_f32 v79, v70, v71
    v_or_b32 v110, v72, v73
    v_or_b32 v111, v74, v75
    v_or_b32 v112, v76, v77
    v_or_b32 v113, v78, v79
    v_or_b32 v110, v110, v111
    v_or_b32 v112, v112, v113
    v_or_b32 v110, v110, v112
    v_and_b32 v110, 0x40004000, v110
    v_cmp_ne_u32 vcc, 0, v110
    s_cbranch_vccnz rare_B7
    v_mfma_f32_32x32x16_bf16 v[24:39], v[96:99], v[72:75], v[24:39]
    v_mfma_f32_32x32x16_bf16 v[24:39], v[100:103], v[76:79], v[24:39]
    s_add_u32 s24, s24, 1
    s_add_u32 s27, s27, 8192
    s_add_u32 s25, s25, 16384
    s_cmp_eq_u32 s25, 49152
    s_cselect_b32 s25, 0, s25
    s_add_u32 s26, s26, 16384
    s_cmp_eq_u32 s26, 49152
    s_cselect_b32 s26, 0, s26
    s_cmp_lt_u32 s24, 8
    s_cbranch_scc1 L_B_stage
    s_branch L_attn_fin
L_attn_A:
    s_lshl_b32 s28, s14, 13
    s_mov_b32 s29, 0
    s_add_u32 s22, s21, s28
    s_add_u32 s23, s22, s16
    s_add_u32 m0, s29, s21
    s_nop 0
    buffer_load_dwordx4 v114, s[8:11], s23 offen lds
    s_add_u32 s23, s22, s17
    s_add_u32 m0, m0, 8192
    s_nop 0
    buffer_load_dwordx4 v114, s[8:11], s23 offen lds
    s_cmp_eq_u32 s14, 0
    s_cbranch_scc1 L_A_nolo
    s_sub_u32 s28, s28, 8192
    s_mov_b32 s29, 16384
    s_add_u32 s22, s21, s28
    s_add_u32 s23, s22, s16
    s_add_u32 m0, s29, s21
    s_nop 0
    buffer_load_dwordx4 v114, s[8:11], s23 offen lds
    s_add_u32 s23, s22, s17
    s_add_u32 m0, m0, 8192
    s_nop 0
    buffer_load_dwordx4 v114, s[8:11], s23 offen lds
L_A_nolo:
    s_waitcnt vmcnt(0) lgkmcnt(0)
    s_barrier
    s_mov_b32 s30, s21
    v_add_u32 v115, s30, v104
    v_mad_u32_u24 v116, s30, v107, v106
    ds_read_b128 v[80:83], v115
    ds_read_b128 v[88:91], v116
    ds_read_b128 v[92:95], v116 offset:512
    s_waitcnt lgkmcnt(0)
    v_mfma_f32_32x32x16_bf16 v[40:55], v[80:83], v[4:7], v[8:23]
    s_nop 7
    s_nop 7
    s_branch rare_Adiag
retry_Adiag:
    v_exp_f32 v40, v40
    v_exp_f32 v41, v41
    v_exp_f32 v42, v42
    v_exp_f32 v43, v43
    v_exp_f32 v44, v44
    v_exp_f32 v45, v45
    v_exp_f32 v46, v46
    v_exp_f32 v47, v47
    v_exp_f32 v48, v48
    v_exp_f32 v49, v49
    v_exp_f32 v50, v50
    v_exp_f32 v51, v51
    v_exp_f32 v52, v52
    v_exp_f32 v53, v53
    v_exp_f32 v54, v54
    v_exp_f32 v55, v55
    v_cvt_pk_bf16_f32 v72, v40, v41
    v_cvt_pk_bf16_f32 v73, v42, v43
    v_cvt_pk_bf16_f32 v74, v44, v45
    v_cvt_pk_bf16_f32 v75, v46, v47
    v_cvt_pk_bf16_f32 v76, v48, v49
    v_cvt_pk_bf16_f32 v77, v50, v51
    v_cvt_pk_bf16_f32 v78, v52, v53
    v_cvt_pk_bf16_f32 v79, v54, v55
    v_or_b32 v110, v72, v73
    v_or_b32 v111, v74, v75
    v_or_b32 v112, v76, v77
    v_or_b32 v113, v78, v79
    v_or_b32 v110, v110, v111
    v_or_b32 v112, v112, v113
    v_or_b32 v110, v110, v112
    v_and_b32 v110, 0x40004000, v110
    v_cmp_ne_u32 vcc, 0, v110
    s_cbranch_vccnz rare_Adiag
    v_mfma_f32_32x32x16_bf16 v[24:39], v[88:91], v[72:75], v[24:39]
    v_mfma_f32_32x32x16_bf16 v[24:39], v[92:95], v[76:79], v[24:39]
    s_mov_b32 s31, 0
L_A_hi:
    s_cmp_ge_u32 s31, s21
    s_cbranch_scc1 L_A_hidone
    s_mov_b32 s30, s31
    v_add_u32 v115, s30, v104
    v_mad_u32_u24 v116, s30, v107, v106
    ds_read_b128 v[80:83], v115
    ds_read_b128 v[88:91], v116
    ds_read_b128 v[92:95], v116 offset:512
    s_waitcnt lgkmcnt(0)
    v_mfma_f32_32x32x16_bf16 v[40:55], v[80:83], v[4:7], v[8:23]
    s_nop 7
    s_nop 7
retry_Ahi:
    v_exp_f32 v40, v40
    v_exp_f32 v41, v41
    v_exp_f32 v42, v42
    v_exp_f32 v43, v43
    v_exp_f32 v44, v44
    v_exp_f32 v45, v45
    v_exp_f32 v46, v46
    v_exp_f32 v47, v47
    v_exp_f32 v48, v48
    v_exp_f32 v49, v49
    v_exp_f32 v50, v50
    v_exp_f32 v51, v51
    v_exp_f32 v52, v52
    v_exp_f32 v53, v53
    v_exp_f32 v54, v54
    v_exp_f32 v55, v55
    v_cvt_pk_bf16_f32 v72, v40, v41
    v_cvt_pk_bf16_f32 v73, v42, v43
    v_cvt_pk_bf16_f32 v74, v44, v45
    v_cvt_pk_bf16_f32 v75, v46, v47
    v_cvt_pk_bf16_f32 v76, v48, v49
    v_cvt_pk_bf16_f32 v77, v50, v51
    v_cvt_pk_bf16_f32 v78, v52, v53
    v_cvt_pk_bf16_f32 v79, v54, v55
    v_or_b32 v110, v72, v73
    v_or_b32 v111, v74, v75
    v_or_b32 v112, v76, v77
    v_or_b32 v113, v78, v79
    v_or_b32 v110, v110, v111
    v_or_b32 v112, v112, v113
    v_or_b32 v110, v110, v112
    v_and_b32 v110, 0x40004000, v110
    v_cmp_ne_u32 vcc, 0, v110
    s_cbranch_vccnz rare_Ahi
    v_mfma_f32_32x32x16_bf16 v[24:39], v[88:91], v[72:75], v[24:39]
    v_mfma_f32_32x32x16_bf16 v[24:39], v[92:95], v[76:79], v[24:39]
    s_add_u32 s31, s31, 1024
    s_branch L_A_hi
L_A_hidone:
    s_cmp_eq_u32 s14, 0
    s_cbranch_scc1 L_attn_fin
    s_add_u32 s31, s21, 1024
L_A_lo:
    s_cmp_ge_u32 s31, 8192
    s_cbranch_scc1 L_A_lodone
    s_add_u32 s30, s31, 16384
    v_add_u32 v115, s30, v104
    v_mad_u32_u24 v116, s30, v107, v106
    ds_read_b128 v[80:83], v115
    ds_read_b128 v[88:91], v116
    ds_read_b128 v[92:95], v116 offset:512
    s_waitcnt lgkmcnt(0)
    v_mfma_f32_32x32x16_bf16 v[40:55], v[80:83], v[4:7], v[8:23]
    s_nop 7
    s_nop 7
retry_Alo:
    v_exp_f32 v40, v40
    v_exp_f32 v41, v41
    v_exp_f32 v42, v42
    v_exp_f32 v43, v43
    v_exp_f32 v44, v44
    v_exp_f32 v45, v45
    v_exp_f32 v46, v46
    v_exp_f32 v47, v47
    v_exp_f32 v48, v48
    v_exp_f32 v49, v49
    v_exp_f32 v50, v50
    v_exp_f32 v51, v51
    v_exp_f32 v52, v52
    v_exp_f32 v53, v53
    v_exp_f32 v54, v54
    v_exp_f32 v55, v55
    v_cvt_pk_bf16_f32 v72, v40, v41
    v_cvt_pk_bf16_f32 v73, v42, v43
    v_cvt_pk_bf16_f32 v74, v44, v45
    v_cvt_pk_bf16_f32 v75, v46, v47
    v_cvt_pk_bf16_f32 v76, v48, v49
    v_cvt_pk_bf16_f32 v77, v50, v51
    v_cvt_pk_bf16_f32 v78, v52, v53
    v_cvt_pk_bf16_f32 v79, v54, v55
    v_or_b32 v110, v72, v73
    v_or_b32 v111, v74, v75
    v_or_b32 v112, v76, v77
    v_or_b32 v113, v78, v79
    v_or_b32 v110, v110, v111
    v_or_b32 v112, v112, v113
    v_or_b32 v110, v110, v112
    v_and_b32 v110, 0x40004000, v110
    v_cmp_ne_u32 vcc, 0, v110
    s_cbranch_vccnz rare_Alo
    v_mfma_f32_32x32x16_bf16 v[24:39], v[88:91], v[72:75], v[24:39]
    v_mfma_f32_32x32x16_bf16 v[24:39], v[92:95], v[76:79], v[24:39]
    s_add_u32 s31, s31, 1024
    s_branch L_A_lo
L_A_lodone:
    s_add_u32 s30, s21, 16384
    v_add_u32 v115, s30, v104
    v_mad_u32_u24 v116, s30, v107, v106
    ds_read_b128 v[80:83], v115
    ds_read_b128 v[88:91], v116
    ds_read_b128 v[92:95], v116 offset:512
    s_waitcnt lgkmcnt(0)
    v_mfma_f32_32x32x16_bf16 v[40:55], v[80:83], v[4:7], v[8:23]
    s_nop 7
    s_nop 7
    v_cmp_lt_i32 vcc, v109, 0
    s_nop 1
    v_cndmask_b32 v40, v117, v40, vcc
    v_cmp_lt_i32 vcc, v109, 1
    s_nop 1
    v_cndmask_b32 v41, v117, v41, vcc
    v_cmp_lt_i32 vcc, v109, 2
    s_nop 1
    v_cndmask_b32 v42, v117, v42, vcc
    v_cmp_lt_i32 vcc, v109, 3
    s_nop 1
    v_cndmask_b32 v43, v117, v43, vcc
    v_cmp_lt_i32 vcc, v109, 8
    s_nop 1
    v_cndmask_b32 v44, v117, v44, vcc
    v_cmp_lt_i32 vcc, v109, 9
    s_nop 1
    v_cndmask_b32 v45, v117, v45, vcc
    v_cmp_lt_i32 vcc, v109, 10
    s_nop 1
    v_cndmask_b32 v46, v117, v46, vcc
    v_cmp_lt_i32 vcc, v109, 11
    s_nop 1
    v_cndmask_b32 v47, v117, v47, vcc
    v_cmp_lt_i32 vcc, v109, 16
    s_nop 1
    v_cndmask_b32 v48, v117, v48, vcc
    v_cmp_lt_i32 vcc, v109, 17
    s_nop 1
    v_cndmask_b32 v49, v117, v49, vcc
    v_cmp_lt_i32 vcc, v109, 18
    s_nop 1
    v_cndmask_b32 v50, v117, v50, vcc
    v_cmp_lt_i32 vcc, v109, 19
    s_nop 1
    v_cndmask_b32 v51, v117, v51, vcc
    v_cmp_lt_i32 vcc, v109, 24
    s_nop 1
    v_cndmask_b32 v52, v117, v52, vcc
    v_cmp_lt_i32 vcc, v109, 25
    s_nop 1
    v_cndmask_b32 v53, v117, v53, vcc
    v_cmp_lt_i32 vcc, v109, 26
    s_nop 1
    v_cndmask_b32 v54, v117, v54, vcc
    v_cmp_lt_i32 vcc, v109, 27
    s_nop 1
    v_cndmask_b32 v55, v117, v55, vcc
retry_Abnd:
    v_exp_f32 v40, v40
    v_exp_f32 v41, v41
    v_exp_f32 v42, v42
    v_exp_f32 v43, v43
    v_exp_f32 v44, v44
    v_exp_f32 v45, v45
    v_exp_f32 v46, v46
    v_exp_f32 v47, v47
    v_exp_f32 v48, v48
    v_exp_f32 v49, v49
    v_exp_f32 v50, v50
    v_exp_f32 v51, v51
    v_exp_f32 v52, v52
    v_exp_f32 v53, v53
    v_exp_f32 v54, v54
    v_exp_f32 v55, v55
    v_cvt_pk_bf16_f32 v72, v40, v41
    v_cvt_pk_bf16_f32 v73, v42, v43
    v_cvt_pk_bf16_f32 v74, v44, v45
    v_cvt_pk_bf16_f32 v75, v46, v47
    v_cvt_pk_bf16_f32 v76, v48, v49
    v_cvt_pk_bf16_f32 v77, v50, v51
    v_cvt_pk_bf16_f32 v78, v52, v53
    v_cvt_pk_bf16_f32 v79, v54, v55
    v_or_b32 v110, v72, v73
    v_or_b32 v111, v74, v75
    v_or_b32 v112, v76, v77
    v_or_b32 v113, v78, v79
    v_or_b32 v110, v110, v111
    v_or_b32 v112, v112, v113
    v_or_b32 v110, v110, v112
    v_and_b32 v110, 0x40004000, v110
    v_cmp_ne_u32 vcc, 0, v110
    s_cbranch_vccnz rare_Abnd
    v_mfma_f32_32x32x16_bf16 v[24:39], v[88:91], v[72:75], v[24:39]
    v_mfma_f32_32x32x16_bf16 v[24:39], v[92:95], v[76:79], v[24:39]
L_attn_fin:
    s_nop 7
    s_nop 7
    v_mov_b32 v110, v32
    v_mov_b32 v111, v32
    s_nop 1
    v_permlane32_swap_b32 v110, v111
    v_rcp_f32 v110, v110
    s_nop 0
    v_mul_f32 v24, v110, v24
    v_mul_f32 v25, v110, v25
    v_mul_f32 v26, v110, v26
    v_mul_f32 v27, v110, v27
    v_mul_f32 v28, v110, v28
    v_mul_f32 v29, v110, v29
    v_mul_f32 v30, v110, v30
    v_mul_f32 v31, v110, v31
    v_cvt_pk_bf16_f32 v72, v24, v25
    v_cvt_pk_bf16_f32 v73, v26, v27
    v_cvt_pk_bf16_f32 v74, v28, v29
    v_cvt_pk_bf16_f32 v75, v30, v31
    s_lshl_b32 s18, s14, 3
    s_add_u32 s18, s18, s15
    s_lshl_b32 s18, s18, 5
    s_add_u32 s18, s18, s13
    s_lshl_b32 s18, s18, 10
    s_lshl_b32 s19, s12, 21
    s_add_u32 s18, s18, s19
    s_add_u32 s18, s18, 12582912
    buffer_store_dwordx4 v[72:75], v104, s[8:11], s18 offen
L_attn_done:
    s_endpgm
rare_B0:
    v_mfma_f32_32x32x16_bf16 v[40:55], v[80:83], v[4:7], v[8:23]
    s_nop 7
    s_nop 7
    v_max3_f32 v110, v40, v41, v42
    v_max3_f32 v110, v110, v43, v44
    v_max3_f32 v110, v110, v45, v46
    v_max3_f32 v110, v110, v47, v48
    v_max3_f32 v110, v110, v49, v50
    v_max3_f32 v110, v110, v51, v52
    v_max3_f32 v110, v110, v53, v54
    v_max_f32 v110, v110, v55
    v_mov_b32 v111, v110
    s_nop 1
    v_permlane32_swap_b32 v110, v111
    v_max_f32 v110, v110, v111
    v_add_f32 v110, 0x41700000, v110
    v_max_f32 v110, v108, v110
    v_sub_f32 v111, v8, v110
    v_mov_b32 v8, v111
    v_mov_b32 v9, v111
    v_mov_b32 v10, v111
    v_mov_b32 v11, v111
    v_mov_b32 v12, v111
    v_mov_b32 v13, v111
    v_mov_b32 v14, v111
    v_mov_b32 v15, v111
    v_mov_b32 v16, v111
    v_mov_b32 v17, v111
    v_mov_b32 v18, v111
    v_mov_b32 v19, v111
    v_mov_b32 v20, v111
    v_mov_b32 v21, v111
    v_mov_b32 v22, v111
    v_mov_b32 v23, v111
    v_max_f32 v110, 0, v110
    v_sub_f32 v110, 0, v110
    v_exp_f32 v110, v110
    v_mov_b32 v108, 0
    s_nop 0
    v_mul_f32 v24, v110, v24
    v_mul_f32 v25, v110, v25
    v_mul_f32 v26, v110, v26
    v_mul_f32 v27, v110, v27
    v_mul_f32 v28, v110, v28
    v_mul_f32 v29, v110, v29
    v_mul_f32 v30, v110, v30
    v_mul_f32 v31, v110, v31
    v_mul_f32 v32, v110, v32
    v_mul_f32 v33, v110, v33
    v_mul_f32 v34, v110, v34
    v_mul_f32 v35, v110, v35
    v_mul_f32 v36, v110, v36
    v_mul_f32 v37, v110, v37
    v_mul_f32 v38, v110, v38
    v_mul_f32 v39, v110, v39
    v_mfma_f32_32x32x16_bf16 v[40:55], v[80:83], v[4:7], v[8:23]
    v_mfma_f32_32x32x16_bf16 v[56:71], v[84:87], v[4:7], v[8:23]
    s_nop 7
    s_nop 7
    s_branch retry_B0

rare_B1:
    v_mfma_f32_32x32x16_bf16 v[56:71], v[84:87], v[4:7], v[8:23]
    s_nop 7
    s_nop 7
    v_max3_f32 v110, v56, v57, v58
    v_max3_f32 v110, v110, v59, v60
    v_max3_f32 v110, v110, v61, v62
    v_max3_f32 v110, v110, v63, v64
    v_max3_f32 v110, v110, v65, v66
    v_max3_f32 v110, v110, v67, v68
    v_max3_f32 v110, v110, v69, v70
    v_max_f32 v110, v110, v71
    v_mov_b32 v111, v110
    s_nop 1
    v_permlane32_swap_b32 v110, v111
    v_max_f32 v110, v110, v111
    v_add_f32 v110, 0x41700000, v110
    v_max_f32 v110, v108, v110
    v_sub_f32 v111, v8, v110
    v_mov_b32 v8, v111
    v_mov_b32 v9, v111
    v_mov_b32 v10, v111
    v_mov_b32 v11, v111
    v_mov_b32 v12, v111
    v_mov_b32 v13, v111
    v_mov_b32 v14, v111
    v_mov_b32 v15, v111
    v_mov_b32 v16, v111
    v_mov_b32 v17, v111
    v_mov_b32 v18, v111
    v_mov_b32 v19, v111
    v_mov_b32 v20, v111
    v_mov_b32 v21, v111
    v_mov_b32 v22, v111
    v_mov_b32 v23, v111
    v_max_f32 v110, 0, v110
    v_sub_f32 v110, 0, v110
    v_exp_f32 v110, v110
    v_mov_b32 v108, 0
    s_nop 0
    v_mul_f32 v24, v110, v24
    v_mul_f32 v25, v110, v25
    v_mul_f32 v26, v110, v26
    v_mul_f32 v27, v110, v27
    v_mul_f32 v28, v110, v28
    v_mul_f32 v29, v110, v29
    v_mul_f32 v30, v110, v30
    v_mul_f32 v31, v110, v31
    v_mul_f32 v32, v110, v32
    v_mul_f32 v33, v110, v33
    v_mul_f32 v34, v110, v34
    v_mul_f32 v35, v110, v35
    v_mul_f32 v36, v110, v36
    v_mul_f32 v37, v110, v37
    v_mul_f32 v38, v110, v38
    v_mul_f32 v39, v110, v39
    v_mfma_f32_32x32x16_bf16 v[56:71], v[84:87], v[4:7], v[8:23]
    v_mfma_f32_32x32x16_bf16 v[40:55], v[80:83], v[4:7], v[8:23]
    s_nop 7
    s_nop 7
    s_branch retry_B1

rare_B2:
    v_mfma_f32_32x32x16_bf16 v[40:55], v[80:83], v[4:7], v[8:23]
    s_nop 7
    s_nop 7
    v_max3_f32 v110, v40, v41, v42
    v_max3_f32 v110, v110, v43, v44
    v_max3_f32 v110, v110, v45, v46
    v_max3_f32 v110, v110, v47, v48
    v_max3_f32 v110, v110, v49, v50
    v_max3_f32 v110, v110, v51, v52
    v_max3_f32 v110, v110, v53, v54
    v_max_f32 v110, v110, v55
    v_mov_b32 v111, v110
    s_nop 1
    v_permlane32_swap_b32 v110, v111
    v_max_f32 v110, v110, v111
    v_add_f32 v110, 0x41700000, v110
    v_max_f32 v110, v108, v110
    v_sub_f32 v111, v8, v110
    v_mov_b32 v8, v111
    v_mov_b32 v9, v111
    v_mov_b32 v10, v111
    v_mov_b32 v11, v111
    v_mov_b32 v12, v111
    v_mov_b32 v13, v111
    v_mov_b32 v14, v111
    v_mov_b32 v15, v111
    v_mov_b32 v16, v111
    v_mov_b32 v17, v111
    v_mov_b32 v18, v111
    v_mov_b32 v19, v111
    v_mov_b32 v20, v111
    v_mov_b32 v21, v111
    v_mov_b32 v22, v111
    v_mov_b32 v23, v111
    v_max_f32 v110, 0, v110
    v_sub_f32 v110, 0, v110
    v_exp_f32 v110, v110
    v_mov_b32 v108, 0
    s_nop 0
    v_mul_f32 v24, v110, v24
    v_mul_f32 v25, v110, v25
    v_mul_f32 v26, v110, v26
    v_mul_f32 v27, v110, v27
    v_mul_f32 v28, v110, v28
    v_mul_f32 v29, v110, v29
    v_mul_f32 v30, v110, v30
    v_mul_f32 v31, v110, v31
    v_mul_f32 v32, v110, v32
    v_mul_f32 v33, v110, v33
    v_mul_f32 v34, v110, v34
    v_mul_f32 v35, v110, v35
    v_mul_f32 v36, v110, v36
    v_mul_f32 v37, v110, v37
    v_mul_f32 v38, v110, v38
    v_mul_f32 v39, v110, v39
    v_mfma_f32_32x32x16_bf16 v[40:55], v[80:83], v[4:7], v[8:23]
    v_mfma_f32_32x32x16_bf16 v[56:71], v[84:87], v[4:7], v[8:23]
    s_nop 7
    s_nop 7
    s_branch retry_B2

rare_B3:
    v_mfma_f32_32x32x16_bf16 v[56:71], v[84:87], v[4:7], v[8:23]
    s_nop 7
    s_nop 7
    v_max3_f32 v110, v56, v57, v58
    v_max3_f32 v110, v110, v59, v60
    v_max3_f32 v110, v110, v61, v62
    v_max3_f32 v110, v110, v63, v64
    v_max3_f32 v110, v110, v65, v66
    v_max3_f32 v110, v110, v67, v68
    v_max3_f32 v110, v110, v69, v70
    v_max_f32 v110, v110, v71
    v_mov_b32 v111, v110
    s_nop 1
    v_permlane32_swap_b32 v110, v111
    v_max_f32 v110, v110, v111
    v_add_f32 v110, 0x41700000, v110
    v_max_f32 v110, v108, v110
    v_sub_f32 v111, v8, v110
    v_mov_b32 v8, v111
    v_mov_b32 v9, v111
    v_mov_b32 v10, v111
    v_mov_b32 v11, v111
    v_mov_b32 v12, v111
    v_mov_b32 v13, v111
    v_mov_b32 v14, v111
    v_mov_b32 v15, v111
    v_mov_b32 v16, v111
    v_mov_b32 v17, v111
    v_mov_b32 v18, v111
    v_mov_b32 v19, v111
    v_mov_b32 v20, v111
    v_mov_b32 v21, v111
    v_mov_b32 v22, v111
    v_mov_b32 v23, v111
    v_max_f32 v110, 0, v110
    v_sub_f32 v110, 0, v110
    v_exp_f32 v110, v110
    v_mov_b32 v108, 0
    s_nop 0
    v_mul_f32 v24, v110, v24
    v_mul_f32 v25, v110, v25
    v_mul_f32 v26, v110, v26
    v_mul_f32 v27, v110, v27
    v_mul_f32 v28, v110, v28
    v_mul_f32 v29, v110, v29
    v_mul_f32 v30, v110, v30
    v_mul_f32 v31, v110, v31
    v_mul_f32 v32, v110, v32
    v_mul_f32 v33, v110, v33
    v_mul_f32 v34, v110, v34
    v_mul_f32 v35, v110, v35
    v_mul_f32 v36, v110, v36
    v_mul_f32 v37, v110, v37
    v_mul_f32 v38, v110, v38
    v_mul_f32 v39, v110, v39
    v_mfma_f32_32x32x16_bf16 v[56:71], v[84:87], v[4:7], v[8:23]
    v_mfma_f32_32x32x16_bf16 v[40:55], v[80:83], v[4:7], v[8:23]
    s_nop 7
    s_nop 7
    s_branch retry_B3

rare_B4:
    v_mfma_f32_32x32x16_bf16 v[40:55], v[80:83], v[4:7], v[8:23]
    s_nop 7
    s_nop 7
    v_max3_f32 v110, v40, v41, v42
    v_max3_f32 v110, v110, v43, v44
    v_max3_f32 v110, v110, v45, v46
    v_max3_f32 v110, v110, v47, v48
    v_max3_f32 v110, v110, v49, v50
    v_max3_f32 v110, v110, v51, v52
    v_max3_f32 v110, v110, v53, v54
    v_max_f32 v110, v110, v55
    v_mov_b32 v111, v110
    s_nop 1
    v_permlane32_swap_b32 v110, v111
    v_max_f32 v110, v110, v111
    v_add_f32 v110, 0x41700000, v110
    v_max_f32 v110, v108, v110
    v_sub_f32 v111, v8, v110
    v_mov_b32 v8, v111
    v_mov_b32 v9, v111
    v_mov_b32 v10, v111
    v_mov_b32 v11, v111
    v_mov_b32 v12, v111
    v_mov_b32 v13, v111
    v_mov_b32 v14, v111
    v_mov_b32 v15, v111
    v_mov_b32 v16, v111
    v_mov_b32 v17, v111
    v_mov_b32 v18, v111
    v_mov_b32 v19, v111
    v_mov_b32 v20, v111
    v_mov_b32 v21, v111
    v_mov_b32 v22, v111
    v_mov_b32 v23, v111
    v_max_f32 v110, 0, v110
    v_sub_f32 v110, 0, v110
    v_exp_f32 v110, v110
    v_mov_b32 v108, 0
    s_nop 0
    v_mul_f32 v24, v110, v24
    v_mul_f32 v25, v110, v25
    v_mul_f32 v26, v110, v26
    v_mul_f32 v27, v110, v27
    v_mul_f32 v28, v110, v28
    v_mul_f32 v29, v110, v29
    v_mul_f32 v30, v110, v30
    v_mul_f32 v31, v110, v31
    v_mul_f32 v32, v110, v32
    v_mul_f32 v33, v110, v33
    v_mul_f32 v34, v110, v34
    v_mul_f32 v35, v110, v35
    v_mul_f32 v36, v110, v36
    v_mul_f32 v37, v110, v37
    v_mul_f32 v38, v110, v38
    v_mul_f32 v39, v110, v39
    v_mfma_f32_32x32x16_bf16 v[40:55], v[80:83], v[4:7], v[8:23]
    v_mfma_f32_32x32x16_bf16 v[56:71], v[84:87], v[4:7], v[8:23]
    s_nop 7
    s_nop 7
    s_branch retry_B4

rare_B5:
    v_mfma_f32_32x32x16_bf16 v[56:71], v[84:87], v[4:7], v[8:23]
    s_nop 7
    s_nop 7
    v_max3_f32 v110, v56, v57, v58
    v_max3_f32 v110, v110, v59, v60
    v_max3_f32 v110, v110, v61, v62
    v_max3_f32 v110, v110, v63, v64
    v_max3_f32 v110, v110, v65, v66
    v_max3_f32 v110, v110, v67, v68
    v_max3_f32 v110, v110, v69, v70
    v_max_f32 v110, v110, v71
    v_mov_b32 v111, v110
    s_nop 1
    v_permlane32_swap_b32 v110, v111
    v_max_f32 v110, v110, v111
    v_add_f32 v110, 0x41700000, v110
    v_max_f32 v110, v108, v110
    v_sub_f32 v111, v8, v110
    v_mov_b32 v8, v111
    v_mov_b32 v9, v111
    v_mov_b32 v10, v111
    v_mov_b32 v11, v111
    v_mov_b32 v12, v111
    v_mov_b32 v13, v111
    v_mov_b32 v14, v111
    v_mov_b32 v15, v111
    v_mov_b32 v16, v111
    v_mov_b32 v17, v111
    v_mov_b32 v18, v111
    v_mov_b32 v19, v111
    v_mov_b32 v20, v111
    v_mov_b32 v21, v111
    v_mov_b32 v22, v111
    v_mov_b32 v23, v111
    v_max_f32 v110, 0, v110
    v_sub_f32 v110, 0, v110
    v_exp_f32 v110, v110
    v_mov_b32 v108, 0
    s_nop 0
    v_mul_f32 v24, v110, v24
    v_mul_f32 v25, v110, v25
    v_mul_f32 v26, v110, v26
    v_mul_f32 v27, v110, v27
    v_mul_f32 v28, v110, v28
    v_mul_f32 v29, v110, v29
    v_mul_f32 v30, v110, v30
    v_mul_f32 v31, v110, v31
    v_mul_f32 v32, v110, v32
    v_mul_f32 v33, v110, v33
    v_mul_f32 v34, v110, v34
    v_mul_f32 v35, v110, v35
    v_mul_f32 v36, v110, v36
    v_mul_f32 v37, v110, v37
    v_mul_f32 v38, v110, v38
    v_mul_f32 v39, v110, v39
    v_mfma_f32_32x32x16_bf16 v[56:71], v[84:87], v[4:7], v[8:23]
    v_mfma_f32_32x32x16_bf16 v[40:55], v[80:83], v[4:7], v[8:23]
    s_nop 7
    s_nop 7
    s_branch retry_B5

rare_B6:
    v_mfma_f32_32x32x16_bf16 v[40:55], v[80:83], v[4:7], v[8:23]
    s_nop 7
    s_nop 7
    v_max3_f32 v110, v40, v41, v42
    v_max3_f32 v110, v110, v43, v44
    v_max3_f32 v110, v110, v45, v46
    v_max3_f32 v110, v110, v47, v48
    v_max3_f32 v110, v110, v49, v50
    v_max3_f32 v110, v110, v51, v52
    v_max3_f32 v110, v110, v53, v54
    v_max_f32 v110, v110, v55
    v_mov_b32 v111, v110
    s_nop 1
    v_permlane32_swap_b32 v110, v111
    v_max_f32 v110, v110, v111
    v_add_f32 v110, 0x41700000, v110
    v_max_f32 v110, v108, v110
    v_sub_f32 v111, v8, v110
    v_mov_b32 v8, v111
    v_mov_b32 v9, v111
    v_mov_b32 v10, v111
    v_mov_b32 v11, v111
    v_mov_b32 v12, v111
    v_mov_b32 v13, v111
    v_mov_b32 v14, v111
    v_mov_b32 v15, v111
    v_mov_b32 v16, v111
    v_mov_b32 v17, v111
    v_mov_b32 v18, v111
    v_mov_b32 v19, v111
    v_mov_b32 v20, v111
    v_mov_b32 v21, v111
    v_mov_b32 v22, v111
    v_mov_b32 v23, v111
    v_max_f32 v110, 0, v110
    v_sub_f32 v110, 0, v110
    v_exp_f32 v110, v110
    v_mov_b32 v108, 0
    s_nop 0
    v_mul_f32 v24, v110, v24
    v_mul_f32 v25, v110, v25
    v_mul_f32 v26, v110, v26
    v_mul_f32 v27, v110, v27
    v_mul_f32 v28, v110, v28
    v_mul_f32 v29, v110, v29
    v_mul_f32 v30, v110, v30
    v_mul_f32 v31, v110, v31
    v_mul_f32 v32, v110, v32
    v_mul_f32 v33, v110, v33
    v_mul_f32 v34, v110, v34
    v_mul_f32 v35, v110, v35
    v_mul_f32 v36, v110, v36
    v_mul_f32 v37, v110, v37
    v_mul_f32 v38, v110, v38
    v_mul_f32 v39, v110, v39
    v_mfma_f32_32x32x16_bf16 v[40:55], v[80:83], v[4:7], v[8:23]
    v_mfma_f32_32x32x16_bf16 v[56:71], v[84:87], v[4:7], v[8:23]
    s_nop 7
    s_nop 7
    s_branch retry_B6

rare_B7:
    v_mfma_f32_32x32x16_bf16 v[56:71], v[84:87], v[4:7], v[8:23]
    s_nop 7
    s_nop 7
    v_max3_f32 v110, v56, v57, v58
    v_max3_f32 v110, v110, v59, v60
    v_max3_f32 v110, v110, v61, v62
    v_max3_f32 v110, v110, v63, v64
    v_max3_f32 v110, v110, v65, v66
    v_max3_f32 v110, v110, v67, v68
    v_max3_f32 v110, v110, v69, v70
    v_max_f32 v110, v110, v71
    v_mov_b32 v111, v110
    s_nop 1
    v_permlane32_swap_b32 v110, v111
    v_max_f32 v110, v110, v111
    v_add_f32 v110, 0x41700000, v110
    v_max_f32 v110, v108, v110
    v_sub_f32 v111, v8, v110
    v_mov_b32 v8, v111
    v_mov_b32 v9, v111
    v_mov_b32 v10, v111
    v_mov_b32 v11, v111
    v_mov_b32 v12, v111
    v_mov_b32 v13, v111
    v_mov_b32 v14, v111
    v_mov_b32 v15, v111
    v_mov_b32 v16, v111
    v_mov_b32 v17, v111
    v_mov_b32 v18, v111
    v_mov_b32 v19, v111
    v_mov_b32 v20, v111
    v_mov_b32 v21, v111
    v_mov_b32 v22, v111
    v_mov_b32 v23, v111
    v_max_f32 v110, 0, v110
    v_sub_f32 v110, 0, v110
    v_exp_f32 v110, v110
    v_mov_b32 v108, 0
    s_nop 0
    v_mul_f32 v24, v110, v24
    v_mul_f32 v25, v110, v25
    v_mul_f32 v26, v110, v26
    v_mul_f32 v27, v110, v27
    v_mul_f32 v28, v110, v28
    v_mul_f32 v29, v110, v29
    v_mul_f32 v30, v110, v30
    v_mul_f32 v31, v110, v31
    v_mul_f32 v32, v110, v32
    v_mul_f32 v33, v110, v33
    v_mul_f32 v34, v110, v34
    v_mul_f32 v35, v110, v35
    v_mul_f32 v36, v110, v36
    v_mul_f32 v37, v110, v37
    v_mul_f32 v38, v110, v38
    v_mul_f32 v39, v110, v39
    v_mfma_f32_32x32x16_bf16 v[56:71], v[84:87], v[4:7], v[8:23]
    s_nop 7
    s_nop 7
    s_branch retry_B7

rare_Adiag:
    v_mfma_f32_32x32x16_bf16 v[40:55], v[80:83], v[4:7], v[8:23]
    s_nop 7
    s_nop 7
    v_cmp_ge_i32 vcc, v109, 0
    s_nop 1
    v_cndmask_b32 v40, v117, v40, vcc
    v_cmp_ge_i32 vcc, v109, 1
    s_nop 1
    v_cndmask_b32 v41, v117, v41, vcc
    v_cmp_ge_i32 vcc, v109, 2
    s_nop 1
    v_cndmask_b32 v42, v117, v42, vcc
    v_cmp_ge_i32 vcc, v109, 3
    s_nop 1
    v_cndmask_b32 v43, v117, v43, vcc
    v_cmp_ge_i32 vcc, v109, 8
    s_nop 1
    v_cndmask_b32 v44, v117, v44, vcc
    v_cmp_ge_i32 vcc, v109, 9
    s_nop 1
    v_cndmask_b32 v45, v117, v45, vcc
    v_cmp_ge_i32 vcc, v109, 10
    s_nop 1
    v_cndmask_b32 v46, v117, v46, vcc
    v_cmp_ge_i32 vcc, v109, 11
    s_nop 1
    v_cndmask_b32 v47, v117, v47, vcc
    v_cmp_ge_i32 vcc, v109, 16
    s_nop 1
    v_cndmask_b32 v48, v117, v48, vcc
    v_cmp_ge_i32 vcc, v109, 17
    s_nop 1
    v_cndmask_b32 v49, v117, v49, vcc
    v_cmp_ge_i32 vcc, v109, 18
    s_nop 1
    v_cndmask_b32 v50, v117, v50, vcc
    v_cmp_ge_i32 vcc, v109, 19
    s_nop 1
    v_cndmask_b32 v51, v117, v51, vcc
    v_cmp_ge_i32 vcc, v109, 24
    s_nop 1
    v_cndmask_b32 v52, v117, v52, vcc
    v_cmp_ge_i32 vcc, v109, 25
    s_nop 1
    v_cndmask_b32 v53, v117, v53, vcc
    v_cmp_ge_i32 vcc, v109, 26
    s_nop 1
    v_cndmask_b32 v54, v117, v54, vcc
    v_cmp_ge_i32 vcc, v109, 27
    s_nop 1
    v_cndmask_b32 v55, v117, v55, vcc
    v_max3_f32 v110, v40, v41, v42
    v_max3_f32 v110, v110, v43, v44
    v_max3_f32 v110, v110, v45, v46
    v_max3_f32 v110, v110, v47, v48
    v_max3_f32 v110, v110, v49, v50
    v_max3_f32 v110, v110, v51, v52
    v_max3_f32 v110, v110, v53, v54
    v_max_f32 v110, v110, v55
    v_mov_b32 v111, v110
    s_nop 1
    v_permlane32_swap_b32 v110, v111
    v_max_f32 v110, v110, v111
    v_add_f32 v110, 0x41700000, v110
    v_max_f32 v110, v108, v110
    v_sub_f32 v111, v8, v110
    v_mov_b32 v8, v111
    v_mov_b32 v9, v111
    v_mov_b32 v10, v111
    v_mov_b32 v11, v111
    v_mov_b32 v12, v111
    v_mov_b32 v13, v111
    v_mov_b32 v14, v111
    v_mov_b32 v15, v111
    v_mov_b32 v16, v111
    v_mov_b32 v17, v111
    v_mov_b32 v18, v111
    v_mov_b32 v19, v111
    v_mov_b32 v20, v111
    v_mov_b32 v21, v111
    v_mov_b32 v22, v111
    v_mov_b32 v23, v111
    v_max_f32 v110, 0, v110
    v_sub_f32 v110, 0, v110
    v_exp_f32 v110, v110
    v_mov_b32 v108, 0
    s_nop 0
    v_mul_f32 v24, v110, v24
    v_mul_f32 v25, v110, v25
    v_mul_f32 v26, v110, v26
    v_mul_f32 v27, v110, v27
    v_mul_f32 v28, v110, v28
    v_mul_f32 v29, v110, v29
    v_mul_f32 v30, v110, v30
    v_mul_f32 v31, v110, v31
    v_mul_f32 v32, v110, v32
    v_mul_f32 v33, v110, v33
    v_mul_f32 v34, v110, v34
    v_mul_f32 v35, v110, v35
    v_mul_f32 v36, v110, v36
    v_mul_f32 v37, v110, v37
    v_mul_f32 v38, v110, v38
    v_mul_f32 v39, v110, v39
    v_mfma_f32_32x32x16_bf16 v[40:55], v[80:83], v[4:7], v[8:23]
    s_nop 7
    s_nop 7
    v_cmp_ge_i32 vcc, v109, 0
    s_nop 1
    v_cndmask_b32 v40, v117, v40, vcc
    v_cmp_ge_i32 vcc, v109, 1
    s_nop 1
    v_cndmask_b32 v41, v117, v41, vcc
    v_cmp_ge_i32 vcc, v109, 2
    s_nop 1
    v_cndmask_b32 v42, v117, v42, vcc
    v_cmp_ge_i32 vcc, v109, 3
    s_nop 1
    v_cndmask_b32 v43, v117, v43, vcc
    v_cmp_ge_i32 vcc, v109, 8
    s_nop 1
    v_cndmask_b32 v44, v117, v44, vcc
    v_cmp_ge_i32 vcc, v109, 9
    s_nop 1
    v_cndmask_b32 v45, v117, v45, vcc
    v_cmp_ge_i32 vcc, v109, 10
    s_nop 1
    v_cndmask_b32 v46, v117, v46, vcc
    v_cmp_ge_i32 vcc, v109, 11
    s_nop 1
    v_cndmask_b32 v47, v117, v47, vcc
    v_cmp_ge_i32 vcc, v109, 16
    s_nop 1
    v_cndmask_b32 v48, v117, v48, vcc
    v_cmp_ge_i32 vcc, v109, 17
    s_nop 1
    v_cndmask_b32 v49, v117, v49, vcc
    v_cmp_ge_i32 vcc, v109, 18
    s_nop 1
    v_cndmask_b32 v50, v117, v50, vcc
    v_cmp_ge_i32 vcc, v109, 19
    s_nop 1
    v_cndmask_b32 v51, v117, v51, vcc
    v_cmp_ge_i32 vcc, v109, 24
    s_nop 1
    v_cndmask_b32 v52, v117, v52, vcc
    v_cmp_ge_i32 vcc, v109, 25
    s_nop 1
    v_cndmask_b32 v53, v117, v53, vcc
    v_cmp_ge_i32 vcc, v109, 26
    s_nop 1
    v_cndmask_b32 v54, v117, v54, vcc
    v_cmp_ge_i32 vcc, v109, 27
    s_nop 1
    v_cndmask_b32 v55, v117, v55, vcc
    s_branch retry_Adiag

rare_Ahi:
    v_mfma_f32_32x32x16_bf16 v[40:55], v[80:83], v[4:7], v[8:23]
    s_nop 7
    s_nop 7
    v_max3_f32 v110, v40, v41, v42
    v_max3_f32 v110, v110, v43, v44
    v_max3_f32 v110, v110, v45, v46
    v_max3_f32 v110, v110, v47, v48
    v_max3_f32 v110, v110, v49, v50
    v_max3_f32 v110, v110, v51, v52
    v_max3_f32 v110, v110, v53, v54
    v_max_f32 v110, v110, v55
    v_mov_b32 v111, v110
    s_nop 1
    v_permlane32_swap_b32 v110, v111
    v_max_f32 v110, v110, v111
    v_add_f32 v110, 0x41700000, v110
    v_max_f32 v110, v108, v110
    v_sub_f32 v111, v8, v110
    v_mov_b32 v8, v111
    v_mov_b32 v9, v111
    v_mov_b32 v10, v111
    v_mov_b32 v11, v111
    v_mov_b32 v12, v111
    v_mov_b32 v13, v111
    v_mov_b32 v14, v111
    v_mov_b32 v15, v111
    v_mov_b32 v16, v111
    v_mov_b32 v17, v111
    v_mov_b32 v18, v111
    v_mov_b32 v19, v111
    v_mov_b32 v20, v111
    v_mov_b32 v21, v111
    v_mov_b32 v22, v111
    v_mov_b32 v23, v111
    v_max_f32 v110, 0, v110
    v_sub_f32 v110, 0, v110
    v_exp_f32 v110, v110
    v_mov_b32 v108, 0
    s_nop 0
    v_mul_f32 v24, v110, v24
    v_mul_f32 v25, v110, v25
    v_mul_f32 v26, v110, v26
    v_mul_f32 v27, v110, v27
    v_mul_f32 v28, v110, v28
    v_mul_f32 v29, v110, v29
    v_mul_f32 v30, v110, v30
    v_mul_f32 v31, v110, v31
    v_mul_f32 v32, v110, v32
    v_mul_f32 v33, v110, v33
    v_mul_f32 v34, v110, v34
    v_mul_f32 v35, v110, v35
    v_mul_f32 v36, v110, v36
    v_mul_f32 v37, v110, v37
    v_mul_f32 v38, v110, v38
    v_mul_f32 v39, v110, v39
    v_mfma_f32_32x32x16_bf16 v[40:55], v[80:83], v[4:7], v[8:23]
    s_nop 7
    s_nop 7
    s_branch retry_Ahi

rare_Alo:
    v_mfma_f32_32x32x16_bf16 v[40:55], v[80:83], v[4:7], v[8:23]
    s_nop 7
    s_nop 7
    v_max3_f32 v110, v40, v41, v42
    v_max3_f32 v110, v110, v43, v44
    v_max3_f32 v110, v110, v45, v46
    v_max3_f32 v110, v110, v47, v48
    v_max3_f32 v110, v110, v49, v50
    v_max3_f32 v110, v110, v51, v52
    v_max3_f32 v110, v110, v53, v54
    v_max_f32 v110, v110, v55
    v_mov_b32 v111, v110
    s_nop 1
    v_permlane32_swap_b32 v110, v111
    v_max_f32 v110, v110, v111
    v_add_f32 v110, 0x41700000, v110
    v_max_f32 v110, v108, v110
    v_sub_f32 v111, v8, v110
    v_mov_b32 v8, v111
    v_mov_b32 v9, v111
    v_mov_b32 v10, v111
    v_mov_b32 v11, v111
    v_mov_b32 v12, v111
    v_mov_b32 v13, v111
    v_mov_b32 v14, v111
    v_mov_b32 v15, v111
    v_mov_b32 v16, v111
    v_mov_b32 v17, v111
    v_mov_b32 v18, v111
    v_mov_b32 v19, v111
    v_mov_b32 v20, v111
    v_mov_b32 v21, v111
    v_mov_b32 v22, v111
    v_mov_b32 v23, v111
    v_max_f32 v110, 0, v110
    v_sub_f32 v110, 0, v110
    v_exp_f32 v110, v110
    v_mov_b32 v108, 0
    s_nop 0
    v_mul_f32 v24, v110, v24
    v_mul_f32 v25, v110, v25
    v_mul_f32 v26, v110, v26
    v_mul_f32 v27, v110, v27
    v_mul_f32 v28, v110, v28
    v_mul_f32 v29, v110, v29
    v_mul_f32 v30, v110, v30
    v_mul_f32 v31, v110, v31
    v_mul_f32 v32, v110, v32
    v_mul_f32 v33, v110, v33
    v_mul_f32 v34, v110, v34
    v_mul_f32 v35, v110, v35
    v_mul_f32 v36, v110, v36
    v_mul_f32 v37, v110, v37
    v_mul_f32 v38, v110, v38
    v_mul_f32 v39, v110, v39
    v_mfma_f32_32x32x16_bf16 v[40:55], v[80:83], v[4:7], v[8:23]
    s_nop 7
    s_nop 7
    s_branch retry_Alo

rare_Abnd:
    v_mfma_f32_32x32x16_bf16 v[40:55], v[80:83], v[4:7], v[8:23]
    s_nop 7
    s_nop 7
    v_cmp_lt_i32 vcc, v109, 0
    s_nop 1
    v_cndmask_b32 v40, v117, v40, vcc
    v_cmp_lt_i32 vcc, v109, 1
    s_nop 1
    v_cndmask_b32 v41, v117, v41, vcc
    v_cmp_lt_i32 vcc, v109, 2
    s_nop 1
    v_cndmask_b32 v42, v117, v42, vcc
    v_cmp_lt_i32 vcc, v109, 3
    s_nop 1
    v_cndmask_b32 v43, v117, v43, vcc
    v_cmp_lt_i32 vcc, v109, 8
    s_nop 1
    v_cndmask_b32 v44, v117, v44, vcc
    v_cmp_lt_i32 vcc, v109, 9
    s_nop 1
    v_cndmask_b32 v45, v117, v45, vcc
    v_cmp_lt_i32 vcc, v109, 10
    s_nop 1
    v_cndmask_b32 v46, v117, v46, vcc
    v_cmp_lt_i32 vcc, v109, 11
    s_nop 1
    v_cndmask_b32 v47, v117, v47, vcc
    v_cmp_lt_i32 vcc, v109, 16
    s_nop 1
    v_cndmask_b32 v48, v117, v48, vcc
    v_cmp_lt_i32 vcc, v109, 17
    s_nop 1
    v_cndmask_b32 v49, v117, v49, vcc
    v_cmp_lt_i32 vcc, v109, 18
    s_nop 1
    v_cndmask_b32 v50, v117, v50, vcc
    v_cmp_lt_i32 vcc, v109, 19
    s_nop 1
    v_cndmask_b32 v51, v117, v51, vcc
    v_cmp_lt_i32 vcc, v109, 24
    s_nop 1
    v_cndmask_b32 v52, v117, v52, vcc
    v_cmp_lt_i32 vcc, v109, 25
    s_nop 1
    v_cndmask_b32 v53, v117, v53, vcc
    v_cmp_lt_i32 vcc, v109, 26
    s_nop 1
    v_cndmask_b32 v54, v117, v54, vcc
    v_cmp_lt_i32 vcc, v109, 27
    s_nop 1
    v_cndmask_b32 v55, v117, v55, vcc
    v_max3_f32 v110, v40, v41, v42
    v_max3_f32 v110, v110, v43, v44
    v_max3_f32 v110, v110, v45, v46
    v_max3_f32 v110, v110, v47, v48
    v_max3_f32 v110, v110, v49, v50
    v_max3_f32 v110, v110, v51, v52
    v_max3_f32 v110, v110, v53, v54
    v_max_f32 v110, v110, v55
    v_mov_b32 v111, v110
    s_nop 1
    v_permlane32_swap_b32 v110, v111
    v_max_f32 v110, v110, v111
    v_add_f32 v110, 0x41700000, v110
    v_max_f32 v110, v108, v110
    v_sub_f32 v111, v8, v110
    v_mov_b32 v8, v111
    v_mov_b32 v9, v111
    v_mov_b32 v10, v111
    v_mov_b32 v11, v111
    v_mov_b32 v12, v111
    v_mov_b32 v13, v111
    v_mov_b32 v14, v111
    v_mov_b32 v15, v111
    v_mov_b32 v16, v111
    v_mov_b32 v17, v111
    v_mov_b32 v18, v111
    v_mov_b32 v19, v111
    v_mov_b32 v20, v111
    v_mov_b32 v21, v111
    v_mov_b32 v22, v111
    v_mov_b32 v23, v111
    v_max_f32 v110, 0, v110
    v_sub_f32 v110, 0, v110
    v_exp_f32 v110, v110
    v_mov_b32 v108, 0
    s_nop 0
    v_mul_f32 v24, v110, v24
    v_mul_f32 v25, v110, v25
    v_mul_f32 v26, v110, v26
    v_mul_f32 v27, v110, v27
    v_mul_f32 v28, v110, v28
    v_mul_f32 v29, v110, v29
    v_mul_f32 v30, v110, v30
    v_mul_f32 v31, v110, v31
    v_mul_f32 v32, v110, v32
    v_mul_f32 v33, v110, v33
    v_mul_f32 v34, v110, v34
    v_mul_f32 v35, v110, v35
    v_mul_f32 v36, v110, v36
    v_mul_f32 v37, v110, v37
    v_mul_f32 v38, v110, v38
    v_mul_f32 v39, v110, v39
    v_mfma_f32_32x32x16_bf16 v[40:55], v[80:83], v[4:7], v[8:23]
    s_nop 7
    s_nop 7
    v_cmp_lt_i32 vcc, v109, 0
    s_nop 1
    v_cndmask_b32 v40, v117, v40, vcc
    v_cmp_lt_i32 vcc, v109, 1
    s_nop 1
    v_cndmask_b32 v41, v117, v41, vcc
    v_cmp_lt_i32 vcc, v109, 2
    s_nop 1
    v_cndmask_b32 v42, v117, v42, vcc
    v_cmp_lt_i32 vcc, v109, 3
    s_nop 1
    v_cndmask_b32 v43, v117, v43, vcc
    v_cmp_lt_i32 vcc, v109, 8
    s_nop 1
    v_cndmask_b32 v44, v117, v44, vcc
    v_cmp_lt_i32 vcc, v109, 9
    s_nop 1
    v_cndmask_b32 v45, v117, v45, vcc
    v_cmp_lt_i32 vcc, v109, 10
    s_nop 1
    v_cndmask_b32 v46, v117, v46, vcc
    v_cmp_lt_i32 vcc, v109, 11
    s_nop 1
    v_cndmask_b32 v47, v117, v47, vcc
    v_cmp_lt_i32 vcc, v109, 16
    s_nop 1
    v_cndmask_b32 v48, v117, v48, vcc
    v_cmp_lt_i32 vcc, v109, 17
    s_nop 1
    v_cndmask_b32 v49, v117, v49, vcc
    v_cmp_lt_i32 vcc, v109, 18
    s_nop 1
    v_cndmask_b32 v50, v117, v50, vcc
    v_cmp_lt_i32 vcc, v109, 19
    s_nop 1
    v_cndmask_b32 v51, v117, v51, vcc
    v_cmp_lt_i32 vcc, v109, 24
    s_nop 1
    v_cndmask_b32 v52, v117, v52, vcc
    v_cmp_lt_i32 vcc, v109, 25
    s_nop 1
    v_cndmask_b32 v53, v117, v53, vcc
    v_cmp_lt_i32 vcc, v109, 26
    s_nop 1
    v_cndmask_b32 v54, v117, v54, vcc
    v_cmp_lt_i32 vcc, v109, 27
    s_nop 1
    v_cndmask_b32 v55, v117, v55, vcc
    s_branch retry_Abnd

.section .rodata,"a"
.p2align 6
.amdhsa_kernel attn_kernel
  .amdhsa_next_free_vgpr 120
  .amdhsa_next_free_sgpr 102
  .amdhsa_accum_offset 120
  .amdhsa_group_segment_fixed_size 0
  .amdhsa_kernarg_size 72
  .amdhsa_user_sgpr_count 2
  .amdhsa_user_sgpr_kernarg_segment_ptr 1
  .amdhsa_system_sgpr_workgroup_id_x 1
.end_amdhsa_kernel
.text

.text
.globl outp_kernel
.p2align 8
.type outp_kernel,@function
outp_kernel:

    s_cmp_ge_u32 s2, 256
    s_cbranch_scc1 L_outp_done
    s_load_dwordx2 s[4:5], s[0:1], 16
    s_load_dwordx2 s[6:7], s[0:1], 40
    s_load_dwordx4 s[24:27], s[0:1], 48
    s_load_dwordx2 s[28:29], s[0:1], 64
    s_lshr_b32 s30, s2, 7
    s_and_b32 s31, s2, 7
    s_bfe_u32 s32, s2, 0x40003
    v_and_b32 v1, 63, v0
    v_lshrrev_b32 v2, 6, v0
    s_nop 0
    v_readfirstlane_b32 s33, v2
    s_waitcnt lgkmcnt(0)
    s_cmp_eq_u32 s30, 0
    s_cselect_b32 s8, s4, s6
    s_cselect_b32 s9, s5, s7
    s_mov_b32 s10, 0x80000
    s_mov_b32 s11, 0x00020000
    s_mov_b32 s12, s28
    s_mov_b32 s13, s29
    s_mov_b32 s14, 16777216
    s_mov_b32 s15, 0x00020000
    s_mov_b32 s16, s24
    s_mov_b32 s17, s25
    s_mov_b32 s18, 0x400000
    s_mov_b32 s19, 0x00020000
    v_lshrrev_b32 v3, 3, v0
    v_and_b32 v4, 7, v0
    v_lshlrev_b32 v5, 10, v3
    v_lshl_add_u32 v5, v4, 4, v5
    s_lshl_b32 s34, s31, 7
    v_add_u32 v5, s34, v5
    v_mul_u32_u24 v6, 192, v3
    v_lshl_add_u32 v6, v4, 4, v6
    v_add_u32 v11, 49152, v6
    s_mov_b32 s35, 0
    buffer_load_dwordx4 v[64:67], v5, s[8:11], s35 offen
    s_mov_b32 s35, 32768
    buffer_load_dwordx4 v[68:71], v5, s[8:11], s35 offen
    s_mov_b32 s35, 65536
    buffer_load_dwordx4 v[72:75], v5, s[8:11], s35 offen
    s_mov_b32 s35, 98304
    buffer_load_dwordx4 v[76:79], v5, s[8:11], s35 offen
    s_mov_b32 s35, 131072
    buffer_load_dwordx4 v[80:83], v5, s[8:11], s35 offen
    s_mov_b32 s35, 163840
    buffer_load_dwordx4 v[84:87], v5, s[8:11], s35 offen
    s_mov_b32 s35, 196608
    buffer_load_dwordx4 v[88:91], v5, s[8:11], s35 offen
    s_mov_b32 s35, 229376
    buffer_load_dwordx4 v[92:95], v5, s[8:11], s35 offen
    s_mov_b32 s35, 262144
    buffer_load_dwordx4 v[96:99], v5, s[8:11], s35 offen
    s_mov_b32 s35, 294912
    buffer_load_dwordx4 v[100:103], v5, s[8:11], s35 offen
    s_mov_b32 s35, 327680
    buffer_load_dwordx4 v[104:107], v5, s[8:11], s35 offen
    s_mov_b32 s35, 360448
    buffer_load_dwordx4 v[108:111], v5, s[8:11], s35 offen
    s_mov_b32 s35, 393216
    buffer_load_dwordx4 v[112:115], v5, s[8:11], s35 offen
    s_mov_b32 s35, 425984
    buffer_load_dwordx4 v[116:119], v5, s[8:11], s35 offen
    s_mov_b32 s35, 458752
    buffer_load_dwordx4 v[120:123], v5, s[8:11], s35 offen
    s_mov_b32 s35, 491520
    buffer_load_dwordx4 v[124:127], v5, s[8:11], s35 offen
    v_and_b32 v3, 31, v1
    v_lshrrev_b32 v4, 5, v1
    v_lshlrev_b32 v7, 4, v3
    v_lshl_add_u32 v7, v4, 9, v7
    s_lshl_b32 s36, s32, 2
    s_add_u32 s36, s36, s33
    s_lshl_b32 s37, s36, 15
    s_lshl_b32 s38, s30, 21
    s_add_u32 s37, s37, s38
    s_add_u32 s37, s37, 12582912
    v_bfe_u32 v8, v1, 2, 2
    v_lshl_add_u32 v8, v4, 2, v8
    v_mul_u32_u24 v8, 192, v8
    v_bfe_u32 v9, v1, 4, 1
    v_lshlrev_b32 v9, 4, v9
    v_and_b32 v10, 3, v1
    v_lshl_add_u32 v9, v10, 2, v9
    v_lshl_add_u32 v8, v9, 1, v8
    v_add_u32 v9, 49152, v8
    v_mov_b32 v128, 0
    v_mov_b32 v129, 0
    v_mov_b32 v130, 0
    v_mov_b32 v131, 0
    v_mov_b32 v132, 0
    v_mov_b32 v133, 0
    v_mov_b32 v134, 0
    v_mov_b32 v135, 0
    v_mov_b32 v136, 0
    v_mov_b32 v137, 0
    v_mov_b32 v138, 0
    v_mov_b32 v139, 0
    v_mov_b32 v140, 0
    v_mov_b32 v141, 0
    v_mov_b32 v142, 0
    v_mov_b32 v143, 0
    v_mov_b32 v144, 0
    v_mov_b32 v145, 0
    v_mov_b32 v146, 0
    v_mov_b32 v147, 0
    v_mov_b32 v148, 0
    v_mov_b32 v149, 0
    v_mov_b32 v150, 0
    v_mov_b32 v151, 0
    v_mov_b32 v152, 0
    v_mov_b32 v153, 0
    v_mov_b32 v154, 0
    v_mov_b32 v155, 0
    v_mov_b32 v156, 0
    v_mov_b32 v157, 0
    v_mov_b32 v158, 0
    v_mov_b32 v159, 0
    s_waitcnt vmcnt(15)
    ds_write_b128 v6, v[64:67] offset:0
    s_waitcnt vmcnt(14)
    ds_write_b128 v6, v[68:71] offset:6144
    s_waitcnt vmcnt(13)
    ds_write_b128 v6, v[72:75] offset:12288
    s_waitcnt vmcnt(12)
    ds_write_b128 v6, v[76:79] offset:18432
    s_waitcnt vmcnt(11)
    ds_write_b128 v6, v[80:83] offset:24576
    s_waitcnt vmcnt(10)
    ds_write_b128 v6, v[84:87] offset:30720
    s_waitcnt vmcnt(9)
    ds_write_b128 v6, v[88:91] offset:36864
    s_waitcnt vmcnt(8)
    ds_write_b128 v6, v[92:95] offset:43008
    s_waitcnt vmcnt(7)
    ds_write_b128 v11, v[96:99] offset:0
    s_waitcnt vmcnt(6)
    ds_write_b128 v11, v[100:103] offset:6144
    s_waitcnt vmcnt(5)
    ds_write_b128 v11, v[104:107] offset:12288
    s_waitcnt vmcnt(4)
    ds_write_b128 v11, v[108:111] offset:18432
    s_waitcnt vmcnt(3)
    ds_write_b128 v11, v[112:115] offset:24576
    s_waitcnt vmcnt(2)
    ds_write_b128 v11, v[116:119] offset:30720
    s_waitcnt vmcnt(1)
    ds_write_b128 v11, v[120:123] offset:36864
    s_waitcnt vmcnt(0)
    ds_write_b128 v11, v[124:127] offset:43008
    s_waitcnt lgkmcnt(0)
    buffer_load_dwordx4 v[64:67], v7, s[12:15], s37 offen offset:0
    buffer_load_dwordx4 v[68:71], v7, s[12:15], s37 offen offset:1024
    buffer_load_dwordx4 v[72:75], v7, s[12:15], s37 offen offset:2048
    buffer_load_dwordx4 v[76:79], v7, s[12:15], s37 offen offset:3072
    s_add_u32 s37, s37, 4096
    buffer_load_dwordx4 v[80:83], v7, s[12:15], s37 offen offset:0
    buffer_load_dwordx4 v[84:87], v7, s[12:15], s37 offen offset:1024
    buffer_load_dwordx4 v[88:91], v7, s[12:15], s37 offen offset:2048
    buffer_load_dwordx4 v[92:95], v7, s[12:15], s37 offen offset:3072
    s_add_u32 s37, s37, 4096
    buffer_load_dwordx4 v[96:99], v7, s[12:15], s37 offen offset:0
    buffer_load_dwordx4 v[100:103], v7, s[12:15], s37 offen offset:1024
    buffer_load_dwordx4 v[104:107], v7, s[12:15], s37 offen offset:2048
    buffer_load_dwordx4 v[108:111], v7, s[12:15], s37 offen offset:3072
    s_add_u32 s37, s37, 4096
    buffer_load_dwordx4 v[112:115], v7, s[12:15], s37 offen offset:0
    buffer_load_dwordx4 v[116:119], v7, s[12:15], s37 offen offset:1024
    buffer_load_dwordx4 v[120:123], v7, s[12:15], s37 offen offset:2048
    buffer_load_dwordx4 v[124:127], v7, s[12:15], s37 offen offset:3072
    s_add_u32 s37, s37, 4096
    s_barrier
    ds_read_b64_tr_b16 v[48:49], v8 offset:0
    ds_read_b64_tr_b16 v[50:51], v8 offset:1536
    ds_read_b64_tr_b16 v[52:53], v8 offset:64
    ds_read_b64_tr_b16 v[54:55], v8 offset:1600
    ds_read_b64_tr_b16 v[56:57], v8 offset:3072
    ds_read_b64_tr_b16 v[58:59], v8 offset:4608
    ds_read_b64_tr_b16 v[60:61], v8 offset:3136
    ds_read_b64_tr_b16 v[62:63], v8 offset:4672
    s_waitcnt vmcnt(15) lgkmcnt(4)
    v_mfma_f32_32x32x16_bf16 v[128:143], v[48:51], v[64:67], v[128:143]
    v_mfma_f32_32x32x16_bf16 v[144:159], v[52:55], v[64:67], v[144:159]
    buffer_load_dwordx4 v[64:67], v7, s[12:15], s37 offen offset:0
    ds_read_b64_tr_b16 v[48:49], v8 offset:6144
    ds_read_b64_tr_b16 v[50:51], v8 offset:7680
    ds_read_b64_tr_b16 v[52:53], v8 offset:6208
    ds_read_b64_tr_b16 v[54:55], v8 offset:7744
    s_waitcnt vmcnt(15) lgkmcnt(4)
    v_mfma_f32_32x32x16_bf16 v[128:143], v[56:59], v[68:71], v[128:143]
    v_mfma_f32_32x32x16_bf16 v[144:159], v[60:63], v[68:71], v[144:159]
    buffer_load_dwordx4 v[68:71], v7, s[12:15], s37 offen offset:1024
    ds_read_b64_tr_b16 v[56:57], v8 offset:9216
    ds_read_b64_tr_b16 v[58:59], v8 offset:10752
    ds_read_b64_tr_b16 v[60:61], v8 offset:9280
    ds_read_b64_tr_b16 v[62:63], v8 offset:10816
    s_waitcnt vmcnt(15) lgkmcnt(4)
    v_mfma_f32_32x32x16_bf16 v[128:143], v[48:51], v[72:75], v[128:143]
    v_mfma_f32_32x32x16_bf16 v[144:159], v[52:55], v[72:75], v[144:159]
    buffer_load_dwordx4 v[72:75], v7, s[12:15], s37 offen offset:2048
    ds_read_b64_tr_b16 v[48:49], v8 offset:12288
    ds_read_b64_tr_b16 v[50:51], v8 offset:13824
    ds_read_b64_tr_b16 v[52:53], v8 offset:12352
    ds_read_b64_tr_b16 v[54:55], v8 offset:13888
    s_waitcnt vmcnt(15) lgkmcnt(4)
    v_mfma_f32_32x32x16_bf16 v[128:143], v[56:59], v[76:79], v[128:143]
    v_mfma_f32_32x32x16_bf16 v[144:159], v[60:63], v[76:79], v[144:159]
    buffer_load_dwordx4 v[76:79], v7, s[12:15], s37 offen offset:3072
    s_add_u32 s37, s37, 4096
    ds_read_b64_tr_b16 v[56:57], v8 offset:15360
    ds_read_b64_tr_b16 v[58:59], v8 offset:16896
    ds_read_b64_tr_b16 v[60:61], v8 offset:15424
    ds_read_b64_tr_b16 v[62:63], v8 offset:16960
    s_waitcnt vmcnt(15) lgkmcnt(4)
    v_mfma_f32_32x32x16_bf16 v[128:143], v[48:51], v[80:83], v[128:143]
    v_mfma_f32_32x32x16_bf16 v[144:159], v[52:55], v[80:83], v[144:159]
    buffer_load_dwordx4 v[80:83], v7, s[12:15], s37 offen offset:0
    ds_read_b64_tr_b16 v[48:49], v8 offset:18432
    ds_read_b64_tr_b16 v[50:51], v8 offset:19968
    ds_read_b64_tr_b16 v[52:53], v8 offset:18496
    ds_read_b64_tr_b16 v[54:55], v8 offset:20032
    s_waitcnt vmcnt(15) lgkmcnt(4)
    v_mfma_f32_32x32x16_bf16 v[128:143], v[56:59], v[84:87], v[128:143]
    v_mfma_f32_32x32x16_bf16 v[144:159], v[60:63], v[84:87], v[144:159]
    buffer_load_dwordx4 v[84:87], v7, s[12:15], s37 offen offset:1024
    ds_read_b64_tr_b16 v[56:57], v8 offset:21504
    ds_read_b64_tr_b16 v[58:59], v8 offset:23040
    ds_read_b64_tr_b16 v[60:61], v8 offset:21568
    ds_read_b64_tr_b16 v[62:63], v8 offset:23104
    s_waitcnt vmcnt(15) lgkmcnt(4)
    v_mfma_f32_32x32x16_bf16 v[128:143], v[48:51], v[88:91], v[128:143]
    v_mfma_f32_32x32x16_bf16 v[144:159], v[52:55], v[88:91], v[144:159]
    buffer_load_dwordx4 v[88:91], v7, s[12:15], s37 offen offset:2048
    ds_read_b64_tr_b16 v[48:49], v8 offset:24576
    ds_read_b64_tr_b16 v[50:51], v8 offset:26112
    ds_read_b64_tr_b16 v[52:53], v8 offset:24640
    ds_read_b64_tr_b16 v[54:55], v8 offset:26176
    s_waitcnt vmcnt(15) lgkmcnt(4)
    v_mfma_f32_32x32x16_bf16 v[128:143], v[56:59], v[92:95], v[128:143]
    v_mfma_f32_32x32x16_bf16 v[144:159], v[60:63], v[92:95], v[144:159]
    buffer_load_dwordx4 v[92:95], v7, s[12:15], s37 offen offset:3072
    s_add_u32 s37, s37, 4096
    ds_read_b64_tr_b16 v[56:57], v8 offset:27648
    ds_read_b64_tr_b16 v[58:59], v8 offset:29184
    ds_read_b64_tr_b16 v[60:61], v8 offset:27712
    ds_read_b64_tr_b16 v[62:63], v8 offset:29248
    s_waitcnt vmcnt(15) lgkmcnt(4)
    v_mfma_f32_32x32x16_bf16 v[128:143], v[48:51], v[96:99], v[128:143]
    v_mfma_f32_32x32x16_bf16 v[144:159], v[52:55], v[96:99], v[144:159]
    buffer_load_dwordx4 v[96:99], v7, s[12:15], s37 offen offset:0
    ds_read_b64_tr_b16 v[48:49], v8 offset:30720
    ds_read_b64_tr_b16 v[50:51], v8 offset:32256
    ds_read_b64_tr_b16 v[52:53], v8 offset:30784
    ds_read_b64_tr_b16 v[54:55], v8 offset:32320
    s_waitcnt vmcnt(15) lgkmcnt(4)
    v_mfma_f32_32x32x16_bf16 v[128:143], v[56:59], v[100:103], v[128:143]
    v_mfma_f32_32x32x16_bf16 v[144:159], v[60:63], v[100:103], v[144:159]
    buffer_load_dwordx4 v[100:103], v7, s[12:15], s37 offen offset:1024
    ds_read_b64_tr_b16 v[56:57], v8 offset:33792
    ds_read_b64_tr_b16 v[58:59], v8 offset:35328
    ds_read_b64_tr_b16 v[60:61], v8 offset:33856
    ds_read_b64_tr_b16 v[62:63], v8 offset:35392
    s_waitcnt vmcnt(15) lgkmcnt(4)
    v_mfma_f32_32x32x16_bf16 v[128:143], v[48:51], v[104:107], v[128:143]
    v_mfma_f32_32x32x16_bf16 v[144:159], v[52:55], v[104:107], v[144:159]
    buffer_load_dwordx4 v[104:107], v7, s[12:15], s37 offen offset:2048
    ds_read_b64_tr_b16 v[48:49], v8 offset:36864
    ds_read_b64_tr_b16 v[50:51], v8 offset:38400
    ds_read_b64_tr_b16 v[52:53], v8 offset:36928
    ds_read_b64_tr_b16 v[54:55], v8 offset:38464
    s_waitcnt vmcnt(15) lgkmcnt(4)
    v_mfma_f32_32x32x16_bf16 v[128:143], v[56:59], v[108:111], v[128:143]
    v_mfma_f32_32x32x16_bf16 v[144:159], v[60:63], v[108:111], v[144:159]
    buffer_load_dwordx4 v[108:111], v7, s[12:15], s37 offen offset:3072
    s_add_u32 s37, s37, 4096
    ds_read_b64_tr_b16 v[56:57], v8 offset:39936
    ds_read_b64_tr_b16 v[58:59], v8 offset:41472
    ds_read_b64_tr_b16 v[60:61], v8 offset:40000
    ds_read_b64_tr_b16 v[62:63], v8 offset:41536
    s_waitcnt vmcnt(15) lgkmcnt(4)
    v_mfma_f32_32x32x16_bf16 v[128:143], v[48:51], v[112:115], v[128:143]
    v_mfma_f32_32x32x16_bf16 v[144:159], v[52:55], v[112:115], v[144:159]
    buffer_load_dwordx4 v[112:115], v7, s[12:15], s37 offen offset:0
    ds_read_b64_tr_b16 v[48:49], v8 offset:43008
    ds_read_b64_tr_b16 v[50:51], v8 offset:44544
    ds_read_b64_tr_b16 v[52:53], v8 offset:43072
    ds_read_b64_tr_b16 v[54:55], v8 offset:44608
    s_waitcnt vmcnt(15) lgkmcnt(4)
    v_mfma_f32_32x32x16_bf16 v[128:143], v[56:59], v[116:119], v[128:143]
    v_mfma_f32_32x32x16_bf16 v[144:159], v[60:63], v[116:119], v[144:159]
    buffer_load_dwordx4 v[116:119], v7, s[12:15], s37 offen offset:1024
    ds_read_b64_tr_b16 v[56:57], v8 offset:46080
    ds_read_b64_tr_b16 v[58:59], v8 offset:47616
    ds_read_b64_tr_b16 v[60:61], v8 offset:46144
    ds_read_b64_tr_b16 v[62:63], v8 offset:47680
    s_waitcnt vmcnt(15) lgkmcnt(4)
    v_mfma_f32_32x32x16_bf16 v[128:143], v[48:51], v[120:123], v[128:143]
    v_mfma_f32_32x32x16_bf16 v[144:159], v[52:55], v[120:123], v[144:159]
    buffer_load_dwordx4 v[120:123], v7, s[12:15], s37 offen offset:2048
    ds_read_b64_tr_b16 v[48:49], v9 offset:0
    ds_read_b64_tr_b16 v[50:51], v9 offset:1536
    ds_read_b64_tr_b16 v[52:53], v9 offset:64
    ds_read_b64_tr_b16 v[54:55], v9 offset:1600
    s_waitcnt vmcnt(15) lgkmcnt(4)
    v_mfma_f32_32x32x16_bf16 v[128:143], v[56:59], v[124:127], v[128:143]
    v_mfma_f32_32x32x16_bf16 v[144:159], v[60:63], v[124:127], v[144:159]
    buffer_load_dwordx4 v[124:127], v7, s[12:15], s37 offen offset:3072
    s_add_u32 s37, s37, 4096
    ds_read_b64_tr_b16 v[56:57], v9 offset:3072
    ds_read_b64_tr_b16 v[58:59], v9 offset:4608
    ds_read_b64_tr_b16 v[60:61], v9 offset:3136
    ds_read_b64_tr_b16 v[62:63], v9 offset:4672
    s_waitcnt vmcnt(15) lgkmcnt(4)
    v_mfma_f32_32x32x16_bf16 v[128:143], v[48:51], v[64:67], v[128:143]
    v_mfma_f32_32x32x16_bf16 v[144:159], v[52:55], v[64:67], v[144:159]
    ds_read_b64_tr_b16 v[48:49], v9 offset:6144
    ds_read_b64_tr_b16 v[50:51], v9 offset:7680
    ds_read_b64_tr_b16 v[52:53], v9 offset:6208
    ds_read_b64_tr_b16 v[54:55], v9 offset:7744
    s_waitcnt vmcnt(14) lgkmcnt(4)
    v_mfma_f32_32x32x16_bf16 v[128:143], v[56:59], v[68:71], v[128:143]
    v_mfma_f32_32x32x16_bf16 v[144:159], v[60:63], v[68:71], v[144:159]
    ds_read_b64_tr_b16 v[56:57], v9 offset:9216
    ds_read_b64_tr_b16 v[58:59], v9 offset:10752
    ds_read_b64_tr_b16 v[60:61], v9 offset:9280
    ds_read_b64_tr_b16 v[62:63], v9 offset:10816
    s_waitcnt vmcnt(13) lgkmcnt(4)
    v_mfma_f32_32x32x16_bf16 v[128:143], v[48:51], v[72:75], v[128:143]
    v_mfma_f32_32x32x16_bf16 v[144:159], v[52:55], v[72:75], v[144:159]
    ds_read_b64_tr_b16 v[48:49], v9 offset:12288
    ds_read_b64_tr_b16 v[50:51], v9 offset:13824
    ds_read_b64_tr_b16 v[52:53], v9 offset:12352
    ds_read_b64_tr_b16 v[54:55], v9 offset:13888
    s_waitcnt vmcnt(12) lgkmcnt(4)
    v_mfma_f32_32x32x16_bf16 v[128:143], v[56:59], v[76:79], v[128:143]
    v_mfma_f32_32x32x16_bf16 v[144:159], v[60:63], v[76:79], v[144:159]
    ds_read_b64_tr_b16 v[56:57], v9 offset:15360
    ds_read_b64_tr_b16 v[58:59], v9 offset:16896
    ds_read_b64_tr_b16 v[60:61], v9 offset:15424
    ds_read_b64_tr_b16 v[62:63], v9 offset:16960
    s_waitcnt vmcnt(11) lgkmcnt(4)
    v_mfma_f32_32x32x16_bf16 v[128:143], v[48:51], v[80:83], v[128:143]
    v_mfma_f32_32x32x16_bf16 v[144:159], v[52:55], v[80:83], v[144:159]
    ds_read_b64_tr_b16 v[48:49], v9 offset:18432
    ds_read_b64_tr_b16 v[50:51], v9 offset:19968
    ds_read_b64_tr_b16 v[52:53], v9 offset:18496
    ds_read_b64_tr_b16 v[54:55], v9 offset:20032
    s_waitcnt vmcnt(10) lgkmcnt(4)
    v_mfma_f32_32x32x16_bf16 v[128:143], v[56:59], v[84:87], v[128:143]
    v_mfma_f32_32x32x16_bf16 v[144:159], v[60:63], v[84:87], v[144:159]
    ds_read_b64_tr_b16 v[56:57], v9 offset:21504
    ds_read_b64_tr_b16 v[58:59], v9 offset:23040
    ds_read_b64_tr_b16 v[60:61], v9 offset:21568
    ds_read_b64_tr_b16 v[62:63], v9 offset:23104
    s_waitcnt vmcnt(9) lgkmcnt(4)
    v_mfma_f32_32x32x16_bf16 v[128:143], v[48:51], v[88:91], v[128:143]
    v_mfma_f32_32x32x16_bf16 v[144:159], v[52:55], v[88:91], v[144:159]
    ds_read_b64_tr_b16 v[48:49], v9 offset:24576
    ds_read_b64_tr_b16 v[50:51], v9 offset:26112
    ds_read_b64_tr_b16 v[52:53], v9 offset:24640
    ds_read_b64_tr_b16 v[54:55], v9 offset:26176
    s_waitcnt vmcnt(8) lgkmcnt(4)
    v_mfma_f32_32x32x16_bf16 v[128:143], v[56:59], v[92:95], v[128:143]
    v_mfma_f32_32x32x16_bf16 v[144:159], v[60:63], v[92:95], v[144:159]
    ds_read_b64_tr_b16 v[56:57], v9 offset:27648
    ds_read_b64_tr_b16 v[58:59], v9 offset:29184
    ds_read_b64_tr_b16 v[60:61], v9 offset:27712
    ds_read_b64_tr_b16 v[62:63], v9 offset:29248
    s_waitcnt vmcnt(7) lgkmcnt(4)
    v_mfma_f32_32x32x16_bf16 v[128:143], v[48:51], v[96:99], v[128:143]
    v_mfma_f32_32x32x16_bf16 v[144:159], v[52:55], v[96:99], v[144:159]
    ds_read_b64_tr_b16 v[48:49], v9 offset:30720
    ds_read_b64_tr_b16 v[50:51], v9 offset:32256
    ds_read_b64_tr_b16 v[52:53], v9 offset:30784
    ds_read_b64_tr_b16 v[54:55], v9 offset:32320
    s_waitcnt vmcnt(6) lgkmcnt(4)
    v_mfma_f32_32x32x16_bf16 v[128:143], v[56:59], v[100:103], v[128:143]
    v_mfma_f32_32x32x16_bf16 v[144:159], v[60:63], v[100:103], v[144:159]
    ds_read_b64_tr_b16 v[56:57], v9 offset:33792
    ds_read_b64_tr_b16 v[58:59], v9 offset:35328
    ds_read_b64_tr_b16 v[60:61], v9 offset:33856
    ds_read_b64_tr_b16 v[62:63], v9 offset:35392
    s_waitcnt vmcnt(5) lgkmcnt(4)
    v_mfma_f32_32x32x16_bf16 v[128:143], v[48:51], v[104:107], v[128:143]
    v_mfma_f32_32x32x16_bf16 v[144:159], v[52:55], v[104:107], v[144:159]
    ds_read_b64_tr_b16 v[48:49], v9 offset:36864
    ds_read_b64_tr_b16 v[50:51], v9 offset:38400
    ds_read_b64_tr_b16 v[52:53], v9 offset:36928
    ds_read_b64_tr_b16 v[54:55], v9 offset:38464
    s_waitcnt vmcnt(4) lgkmcnt(4)
    v_mfma_f32_32x32x16_bf16 v[128:143], v[56:59], v[108:111], v[128:143]
    v_mfma_f32_32x32x16_bf16 v[144:159], v[60:63], v[108:111], v[144:159]
    ds_read_b64_tr_b16 v[56:57], v9 offset:39936
    ds_read_b64_tr_b16 v[58:59], v9 offset:41472
    ds_read_b64_tr_b16 v[60:61], v9 offset:40000
    ds_read_b64_tr_b16 v[62:63], v9 offset:41536
    s_waitcnt vmcnt(3) lgkmcnt(4)
    v_mfma_f32_32x32x16_bf16 v[128:143], v[48:51], v[112:115], v[128:143]
    v_mfma_f32_32x32x16_bf16 v[144:159], v[52:55], v[112:115], v[144:159]
    ds_read_b64_tr_b16 v[48:49], v9 offset:43008
    ds_read_b64_tr_b16 v[50:51], v9 offset:44544
    ds_read_b64_tr_b16 v[52:53], v9 offset:43072
    ds_read_b64_tr_b16 v[54:55], v9 offset:44608
    s_waitcnt vmcnt(2) lgkmcnt(4)
    v_mfma_f32_32x32x16_bf16 v[128:143], v[56:59], v[116:119], v[128:143]
    v_mfma_f32_32x32x16_bf16 v[144:159], v[60:63], v[116:119], v[144:159]
    ds_read_b64_tr_b16 v[56:57], v9 offset:46080
    ds_read_b64_tr_b16 v[58:59], v9 offset:47616
    ds_read_b64_tr_b16 v[60:61], v9 offset:46144
    ds_read_b64_tr_b16 v[62:63], v9 offset:47680
    s_waitcnt vmcnt(1) lgkmcnt(4)
    v_mfma_f32_32x32x16_bf16 v[128:143], v[48:51], v[120:123], v[128:143]
    v_mfma_f32_32x32x16_bf16 v[144:159], v[52:55], v[120:123], v[144:159]
    s_waitcnt vmcnt(0) lgkmcnt(0)
    v_mfma_f32_32x32x16_bf16 v[128:143], v[56:59], v[124:127], v[128:143]
    v_mfma_f32_32x32x16_bf16 v[144:159], v[60:63], v[124:127], v[144:159]
    s_nop 7
    s_nop 7
    v_lshlrev_b32 v5, 11, v3
    v_lshl_add_u32 v5, v4, 3, v5
    s_lshl_b32 s34, s36, 16
    s_lshl_b32 s35, s30, 10
    s_add_u32 s34, s34, s35
    s_lshl_b32 s35, s31, 7
    s_add_u32 s34, s34, s35
    v_cvt_pk_bf16_f32 v32, v128, v129
    v_cvt_pk_bf16_f32 v33, v130, v131
    buffer_store_dwordx2 v[32:33], v5, s[16:19], s34 offen offset:0
    v_cvt_pk_bf16_f32 v34, v132, v133
    v_cvt_pk_bf16_f32 v35, v134, v135
    buffer_store_dwordx2 v[34:35], v5, s[16:19], s34 offen offset:16
    v_cvt_pk_bf16_f32 v36, v136, v137
    v_cvt_pk_bf16_f32 v37, v138, v139
    buffer_store_dwordx2 v[36:37], v5, s[16:19], s34 offen offset:32
    v_cvt_pk_bf16_f32 v38, v140, v141
    v_cvt_pk_bf16_f32 v39, v142, v143
    buffer_store_dwordx2 v[38:39], v5, s[16:19], s34 offen offset:48
    v_cvt_pk_bf16_f32 v40, v144, v145
    v_cvt_pk_bf16_f32 v41, v146, v147
    buffer_store_dwordx2 v[40:41], v5, s[16:19], s34 offen offset:64
    v_cvt_pk_bf16_f32 v42, v148, v149
    v_cvt_pk_bf16_f32 v43, v150, v151
    buffer_store_dwordx2 v[42:43], v5, s[16:19], s34 offen offset:80
    v_cvt_pk_bf16_f32 v44, v152, v153
    v_cvt_pk_bf16_f32 v45, v154, v155
    buffer_store_dwordx2 v[44:45], v5, s[16:19], s34 offen offset:96
    v_cvt_pk_bf16_f32 v46, v156, v157
    v_cvt_pk_bf16_f32 v47, v158, v159
    buffer_store_dwordx2 v[46:47], v5, s[16:19], s34 offen offset:112
L_outp_done:
    s_endpgm
.section .rodata,"a"
.p2align 6
.amdhsa_kernel outp_kernel
  .amdhsa_next_free_vgpr 160
  .amdhsa_next_free_sgpr 102
  .amdhsa_accum_offset 160
  .amdhsa_group_segment_fixed_size 0
  .amdhsa_kernarg_size 72
  .amdhsa_user_sgpr_count 2
  .amdhsa_user_sgpr_kernarg_segment_ptr 1
  .amdhsa_system_sgpr_workgroup_id_x 1
.end_amdhsa_kernel
.text
```
